```python
import torch

def _softmax(x, axis=-1):
    return torch.softmax(x, dim=axis)
def _gelu(x):
    return torch.nn.functional.gelu(x, approximate="tanh")
def _silu(x):
    return torch.nn.functional.silu(x)
def _sigmoid(x):
    return torch.sigmoid(x)
def _layernorm(x, axis=-1, eps=1e-5):
    m = x.mean(dim=axis, keepdim=True)
    v = x.var(dim=axis, keepdim=True, unbiased=False)
    return (x - m) / torch.sqrt(v + eps)
def _scatter_add(tgt, idx, src, axis=0):
    return tgt.clone().index_add_(axis, idx, src)
def _segment_sum(src, seg, n):
    out = torch.zeros((n,) + src.shape[1:], dtype=src.dtype)
    return out.index_add_(0, seg, src)
def _pad(x, pw):
    flat = tuple(v for pair in reversed(pw) for v in pair)
    return torch.nn.functional.pad(x, flat)

kernel_name = 'gated_mix__gqa_block_cached__gqa_block_cached__decode'

def setup_inputs():

    _w = (lambda a: (lambda t: t.to(torch.bfloat16) if t.is_floating_point() else t)(torch.as_tensor(a)))
    def _A_setup():
        B, Sq, D = 2, 1, 448
        Hq, Hkv, Sk, Dh = 16, 8, 8192, 256
        assert Hq % Hkv == 0, (Hq, Hkv)
        return {
            "x": _w((lambda *s: torch.randn(*s, dtype=torch.bfloat16) * 0.05)(B, Sq, D)),
            "k_cache": _w((lambda *s: torch.randn(*s, dtype=torch.bfloat16) * 6.4)(B, Hkv, Sk, Dh)),
            "v_cache": _w((lambda *s: torch.randn(*s, dtype=torch.bfloat16) * 0.05)(B, Hkv, Sk, Dh)),
            "wq": _w((lambda *s: torch.randn(*s, dtype=torch.bfloat16) * 6.4)(D, Hq * Dh) * (D ** -0.5)),
            "wo": _w((lambda *s: torch.randn(*s, dtype=torch.bfloat16) * 0.05)(Hq * Dh, D) * ((Hq * Dh) ** -0.5)),
        }
    _A_in = _A_setup()

    def _B_setup():
        B, Sq, D = 2, 1, 448
        Hq, Hkv, Sk, Dh = 16, 8, 8192, 256
        assert Hq % Hkv == 0, (Hq, Hkv)
        return {
            "x": _w((lambda *s: torch.randn(*s, dtype=torch.bfloat16) * 0.05)(B, Sq, D)),
            "k_cache": _w((lambda *s: torch.randn(*s, dtype=torch.bfloat16) * 6.4)(B, Hkv, Sk, Dh)),
            "v_cache": _w((lambda *s: torch.randn(*s, dtype=torch.bfloat16) * 0.05)(B, Hkv, Sk, Dh)),
            "wq": _w((lambda *s: torch.randn(*s, dtype=torch.bfloat16) * 6.4)(D, Hq * Dh) * (D ** -0.5)),
            "wo": _w((lambda *s: torch.randn(*s, dtype=torch.bfloat16) * 0.05)(Hq * Dh, D) * ((Hq * Dh) ** -0.5)),
        }
    _B_in = _B_setup()

    return {
        "A_x": _A_in["x"],
        "A_k_cache": _A_in["k_cache"],
        "A_v_cache": _A_in["v_cache"],
        "A_wq": _A_in["wq"],
        "A_wo": _A_in["wo"],
        "B_x": _B_in["x"],
        "B_k_cache": _B_in["k_cache"],
        "B_v_cache": _B_in["v_cache"],
        "B_wq": _B_in["wq"],
        "B_wo": _B_in["wo"],
        "gate_w": _w((lambda *s: torch.randn(*s, dtype=torch.bfloat16) * 0.05)(448) * 16.0),
    }

def reference(A_x, A_k_cache, A_v_cache, A_wq, A_wo, B_x, B_k_cache, B_v_cache, B_wq, B_wo, gate_w):
    def _A_ref(x, k_cache, v_cache, wq, wo):
        B, Sq, D = x.shape
        Hq, Dh = 16, 256
        Hkv = k_cache.shape[1]
        rep = Hq // Hkv
        q = (lambda x, *d: x.permute(*d))((x @ wq).reshape(B, Sq, Hq, Dh), 0, 2, 1, 3)
        k = (lambda x, n, axis: torch.repeat_interleave(x, n, dim=axis))(k_cache, rep, axis=1)
        v = (lambda x, n, axis: torch.repeat_interleave(x, n, dim=axis))(v_cache, rep, axis=1)
        scores = torch.einsum("bhqd,bhkd->bhqk", q, k) * (Dh ** -0.5)
        p = _softmax(scores, axis=-1)
        o = torch.einsum("bhqk,bhkd->bhqd", p, v)
        return (lambda x, *d: x.permute(*d))(o, 0, 2, 1, 3).reshape(B, Sq, Hq * Dh) @ wo

    def _B_ref(x, k_cache, v_cache, wq, wo):
        B, Sq, D = x.shape
        Hq, Dh = 16, 256
        Hkv = k_cache.shape[1]
        rep = Hq // Hkv
        q = (lambda x, *d: x.permute(*d))((x @ wq).reshape(B, Sq, Hq, Dh), 0, 2, 1, 3)
        k = (lambda x, n, axis: torch.repeat_interleave(x, n, dim=axis))(k_cache, rep, axis=1)
        v = (lambda x, n, axis: torch.repeat_interleave(x, n, dim=axis))(v_cache, rep, axis=1)
        scores = torch.einsum("bhqd,bhkd->bhqk", q, k) * (Dh ** -0.5)
        p = _softmax(scores, axis=-1)
        o = torch.einsum("bhqk,bhkd->bhqd", p, v)
        return (lambda x, *d: x.permute(*d))(o, 0, 2, 1, 3).reshape(B, Sq, Hq * Dh) @ wo

    x = A_x
    g = _sigmoid((x * gate_w).sum(-1, keepdims=True))
    a = _A_ref(x, A_k_cache, A_v_cache, A_wq, A_wo)
    b = _B_ref(x, B_k_cache, B_v_cache, B_wq, B_wo)
    return g * a + (1 - g) * b
```

```asm
; @launch grid=(256,1,1) block=(512,1,1) lds=98304
.amdgcn_target "amdgcn-amd-amdhsa--gfx950"
.text
.globl gated_mix__gqa_block_cached__gqa_block_cached__decode_kernel
.p2align 8
.type gated_mix__gqa_block_cached__gqa_block_cached__decode_kernel,@function
gated_mix__gqa_block_cached__gqa_block_cached__decode_kernel:
    s_cmp_ge_u32 s2, 256
    s_cbranch_scc1 L_end
    s_memrealtime s[92:93]
    s_load_dwordx16 s[16:31], s[0:1], 0
    s_load_dwordx8 s[32:39], s[0:1], 64
    s_load_dwordx4 s[40:43], s[0:1], 96
    v_lshrrev_b32 v1, 6, v0
    v_and_b32 v2, 63, v0
    v_readfirstlane_b32 s9, v1
    s_bfe_u32 s15, s2, 0x20006
    s_lshl_b32 s3, s15, 2
    s_bfe_u32 s15, s2, 0x20001
    s_add_u32 s3, s3, s15
    s_bfe_u32 s5, s2, 0x10005
    s_bfe_u32 s15, s2, 0x20003
    s_lshl_b32 s6, s15, 1
    s_and_b32 s15, s2, 1
    s_add_u32 s6, s6, s15
    s_lshr_b32 s7, s3, 3
    s_and_b32 s8, s3, 7
    s_lshl_b32 s4, s5, 3
    s_add_u32 s4, s4, s6
    s_and_b32 s86, s2, 1
    s_lshl_b32 s86, s86, 3
    s_lshl_b32 s15, s5, 2
    s_add_u32 s86, s86, s15
    s_lshr_b32 s15, s6, 1
    s_add_u32 s86, s86, s15
    v_and_b32 v3, 15, v2
    v_lshrrev_b32 v4, 4, v2
    v_lshrrev_b32 v11, 2, v3
    v_lshlrev_b32 v11, 9, v11
    v_and_b32 v12, 3, v3
    v_lshlrev_b32 v12, 4, v12
    v_lshlrev_b32 v13, 6, v4
    v_add3_u32 v5, v11, v12, v13
    v_lshlrev_b32 v11, 9, v4
    v_lshlrev_b32 v12, 4, v3
    v_add_u32 v6, v11, v12
    s_mov_b32 s80, 0x05040100
    s_mov_b32 s81, 0x07060302
    s_mov_b32 s82, 0x3db8aa3b
    s_mov_b32 s83, 0x9E3779B9
    s_mov_b32 s84, 0x00030003
    s_mov_b32 s85, 0x00030003
    v_cndmask_b32 v10, 0, -1, s[84:85]
    s_lshr_b32 s12, s6, 1
    s_lshl_b32 s12, s12, 7
    s_add_u32 s12, s12, s9
    s_and_b32 s15, s6, 1
    s_mul_i32 s15, s15, 96
    s_add_u32 s12, s12, s15
    s_getreg_b32 s87, hwreg(HW_REG_XCC_ID, 0, 1)
    s_lshl_b32 s15, s5, 3
    s_add_u32 s15, s15, s8
    s_lshl_b32 s15, s15, 22
    s_waitcnt lgkmcnt(0)
    s_cmp_eq_u32 s7, 0
    s_cselect_b32 s52, s22, s32
    s_cselect_b32 s53, s23, s33
    s_cselect_b32 s44, s18, s28
    s_cselect_b32 s45, s19, s29
    s_cselect_b32 s48, s20, s30
    s_cselect_b32 s49, s21, s31
    s_cselect_b32 s56, s24, s34
    s_cselect_b32 s57, s25, s35
    s_add_u32 s44, s44, s15
    s_addc_u32 s45, s45, 0
    s_mov_b32 s46, 0x400000
    s_mov_b32 s47, 0x20000
    s_add_u32 s48, s48, s15
    s_addc_u32 s49, s49, 0
    s_mov_b32 s50, 0x400000
    s_mov_b32 s51, 0x20000
    s_mov_b32 s54, 3670016
    s_mov_b32 s55, 0x20000
    s_mov_b32 s58, 3670016
    s_mov_b32 s59, 0x20000
    s_mov_b32 s60, s42
    s_mov_b32 s61, s43
    s_mov_b32 s62, 8388608
    s_mov_b32 s63, 0x20000
    s_mov_b32 s64, s16
    s_mov_b32 s65, s17
    s_mov_b32 s66, 1792
    s_mov_b32 s67, 0x20000
    s_mov_b32 s68, s36
    s_mov_b32 s69, s37
    s_mov_b32 s70, 896
    s_mov_b32 s71, 0x20000
    s_mov_b32 s72, s38
    s_mov_b32 s73, s39
    s_mov_b32 s74, 1792
    s_mov_b32 s75, 0x20000
    s_mov_b32 s76, s40
    s_mov_b32 s77, s41
    s_mov_b32 s78, 256
    s_mov_b32 s79, 0x20000
    s_cmp_eq_u32 s9, 0
    s_cbranch_scc1 L_helper
    s_cmp_lt_u32 s9, 5
    s_cbranch_scc1 L_qproj
    s_barrier
    s_add_u32 s10, s12, 0
    s_lshl_b32 s10, s10, 13
    s_add_u32 s11, s10, 4096
    buffer_load_dwordx4 v[16:19], v5, s[44:47], s10 offen offset:0 nt
    buffer_load_dwordx4 v[20:23], v5, s[44:47], s10 offen offset:256 nt
    buffer_load_dwordx4 v[24:27], v5, s[44:47], s10 offen offset:2048 nt
    buffer_load_dwordx4 v[28:31], v5, s[44:47], s10 offen offset:2304 nt
    buffer_load_dwordx4 v[32:35], v5, s[44:47], s11 offen offset:0 nt
    buffer_load_dwordx4 v[36:39], v5, s[44:47], s11 offen offset:256 nt
    buffer_load_dwordx4 v[40:43], v5, s[44:47], s11 offen offset:2048 nt
    buffer_load_dwordx4 v[44:47], v5, s[44:47], s11 offen offset:2304 nt
    s_add_u32 s10, s12, 8
    s_lshl_b32 s10, s10, 13
    s_add_u32 s11, s10, 4096
    buffer_load_dwordx4 v[48:51], v5, s[44:47], s10 offen offset:0 nt
    buffer_load_dwordx4 v[52:55], v5, s[44:47], s10 offen offset:256 nt
    buffer_load_dwordx4 v[56:59], v5, s[44:47], s10 offen offset:2048 nt
    buffer_load_dwordx4 v[60:63], v5, s[44:47], s10 offen offset:2304 nt
    buffer_load_dwordx4 v[64:67], v5, s[44:47], s11 offen offset:0 nt
    buffer_load_dwordx4 v[68:71], v5, s[44:47], s11 offen offset:256 nt
    buffer_load_dwordx4 v[72:75], v5, s[44:47], s11 offen offset:2048 nt
    buffer_load_dwordx4 v[76:79], v5, s[44:47], s11 offen offset:2304 nt
    s_barrier
    s_add_u32 s10, s12, 16
    s_lshl_b32 s10, s10, 13
    s_add_u32 s11, s10, 4096
    buffer_load_dwordx4 v[80:83], v5, s[44:47], s10 offen offset:0 nt
    buffer_load_dwordx4 v[84:87], v5, s[44:47], s10 offen offset:256 nt
    buffer_load_dwordx4 v[88:91], v5, s[44:47], s10 offen offset:2048 nt
    buffer_load_dwordx4 v[92:95], v5, s[44:47], s10 offen offset:2304 nt
    buffer_load_dwordx4 v[96:99], v5, s[44:47], s11 offen offset:0 nt
    buffer_load_dwordx4 v[100:103], v5, s[44:47], s11 offen offset:256 nt
    buffer_load_dwordx4 v[104:107], v5, s[44:47], s11 offen offset:2048 nt
    buffer_load_dwordx4 v[108:111], v5, s[44:47], s11 offen offset:2304 nt
    s_add_u32 s10, s12, 24
    s_lshl_b32 s10, s10, 13
    s_add_u32 s11, s10, 4096
    buffer_load_dwordx4 v[112:115], v5, s[44:47], s10 offen offset:0 nt
    buffer_load_dwordx4 v[116:119], v5, s[44:47], s10 offen offset:256 nt
    buffer_load_dwordx4 v[120:123], v5, s[44:47], s10 offen offset:2048 nt
    buffer_load_dwordx4 v[124:127], v5, s[44:47], s10 offen offset:2304 nt
    buffer_load_dwordx4 v[128:131], v5, s[44:47], s11 offen offset:0 nt
    buffer_load_dwordx4 v[132:135], v5, s[44:47], s11 offen offset:256 nt
    buffer_load_dwordx4 v[136:139], v5, s[44:47], s11 offen offset:2048 nt
    buffer_load_dwordx4 v[140:143], v5, s[44:47], s11 offen offset:2304 nt
    s_branch L_qwait
L_qproj:
    s_sub_u32 s14, s9, 1
    v_lshrrev_b32 v11, 2, v2
    v_and_b32 v12, 3, v2
    s_lshl_b32 s15, s14, 7
    v_lshlrev_b32 v11, 3, v11
    v_add_u32 v11, s15, v11
    v_lshlrev_b32 v13, 1, v11
    v_lshlrev_b32 v11, 13, v11
    v_lshlrev_b32 v12, 4, v12
    v_add_u32 v14, v11, v12
    s_lshl_b32 s15, s8, 10
    s_lshl_b32 s88, s86, 6
    s_add_u32 s15, s15, s88
    buffer_load_dwordx4 v[16:19], v14, s[52:55], s15 offen nt
    s_add_u32 s15, s15, 8192
    buffer_load_dwordx4 v[20:23], v14, s[52:55], s15 offen nt
    s_add_u32 s15, s15, 8192
    buffer_load_dwordx4 v[24:27], v14, s[52:55], s15 offen nt
    s_add_u32 s15, s15, 8192
    buffer_load_dwordx4 v[28:31], v14, s[52:55], s15 offen nt
    s_add_u32 s15, s15, 8192
    buffer_load_dwordx4 v[32:35], v14, s[52:55], s15 offen nt
    s_add_u32 s15, s15, 8192
    buffer_load_dwordx4 v[36:39], v14, s[52:55], s15 offen nt
    s_add_u32 s15, s15, 8192
    buffer_load_dwordx4 v[40:43], v14, s[52:55], s15 offen nt
    s_add_u32 s15, s15, 8192
    buffer_load_dwordx4 v[44:47], v14, s[52:55], s15 offen nt
    buffer_load_dwordx4 v[176:179], v13, s[64:67], 0 offen
    buffer_load_dwordx4 v[180:183], v13, s[64:67], 0 offen offset:896
    s_barrier
    v_mov_b32 v144, 0
    v_mov_b32 v145, 0
    v_mov_b32 v146, 0
    v_mov_b32 v147, 0
    v_mov_b32 v148, 0
    v_mov_b32 v149, 0
    v_mov_b32 v150, 0
    v_mov_b32 v151, 0
    v_mov_b32 v152, 0
    v_mov_b32 v153, 0
    v_mov_b32 v154, 0
    v_mov_b32 v155, 0
    v_mov_b32 v156, 0
    v_mov_b32 v157, 0
    v_mov_b32 v158, 0
    v_mov_b32 v159, 0
    s_waitcnt vmcnt(0)
    v_perm_b32 v184, v20, v16, s80
    v_perm_b32 v185, v20, v16, s81
    v_perm_b32 v186, v21, v17, s80
    v_perm_b32 v187, v21, v17, s81
    v_perm_b32 v188, v22, v18, s80
    v_perm_b32 v189, v22, v18, s81
    v_perm_b32 v190, v23, v19, s80
    v_perm_b32 v191, v23, v19, s81
    v_dot2_f32_bf16 v144, v184, v176, v144
    v_dot2_f32_bf16 v145, v185, v176, v145
    v_dot2_f32_bf16 v146, v186, v176, v146
    v_dot2_f32_bf16 v147, v187, v176, v147
    v_dot2_f32_bf16 v148, v188, v176, v148
    v_dot2_f32_bf16 v149, v189, v176, v149
    v_dot2_f32_bf16 v150, v190, v176, v150
    v_dot2_f32_bf16 v151, v191, v176, v151
    v_dot2_f32_bf16 v152, v184, v180, v152
    v_dot2_f32_bf16 v153, v185, v180, v153
    v_dot2_f32_bf16 v154, v186, v180, v154
    v_dot2_f32_bf16 v155, v187, v180, v155
    v_dot2_f32_bf16 v156, v188, v180, v156
    v_dot2_f32_bf16 v157, v189, v180, v157
    v_dot2_f32_bf16 v158, v190, v180, v158
    v_dot2_f32_bf16 v159, v191, v180, v159
    v_perm_b32 v184, v28, v24, s80
    v_perm_b32 v185, v28, v24, s81
    v_perm_b32 v186, v29, v25, s80
    v_perm_b32 v187, v29, v25, s81
    v_perm_b32 v188, v30, v26, s80
    v_perm_b32 v189, v30, v26, s81
    v_perm_b32 v190, v31, v27, s80
    v_perm_b32 v191, v31, v27, s81
    v_dot2_f32_bf16 v144, v184, v177, v144
    v_dot2_f32_bf16 v145, v185, v177, v145
    v_dot2_f32_bf16 v146, v186, v177, v146
    v_dot2_f32_bf16 v147, v187, v177, v147
    v_dot2_f32_bf16 v148, v188, v177, v148
    v_dot2_f32_bf16 v149, v189, v177, v149
    v_dot2_f32_bf16 v150, v190, v177, v150
    v_dot2_f32_bf16 v151, v191, v177, v151
    v_dot2_f32_bf16 v152, v184, v181, v152
    v_dot2_f32_bf16 v153, v185, v181, v153
    v_dot2_f32_bf16 v154, v186, v181, v154
    v_dot2_f32_bf16 v155, v187, v181, v155
    v_dot2_f32_bf16 v156, v188, v181, v156
    v_dot2_f32_bf16 v157, v189, v181, v157
    v_dot2_f32_bf16 v158, v190, v181, v158
    v_dot2_f32_bf16 v159, v191, v181, v159
    v_perm_b32 v184, v36, v32, s80
    v_perm_b32 v185, v36, v32, s81
    v_perm_b32 v186, v37, v33, s80
    v_perm_b32 v187, v37, v33, s81
    v_perm_b32 v188, v38, v34, s80
    v_perm_b32 v189, v38, v34, s81
    v_perm_b32 v190, v39, v35, s80
    v_perm_b32 v191, v39, v35, s81
    v_dot2_f32_bf16 v144, v184, v178, v144
    v_dot2_f32_bf16 v145, v185, v178, v145
    v_dot2_f32_bf16 v146, v186, v178, v146
    v_dot2_f32_bf16 v147, v187, v178, v147
    v_dot2_f32_bf16 v148, v188, v178, v148
    v_dot2_f32_bf16 v149, v189, v178, v149
    v_dot2_f32_bf16 v150, v190, v178, v150
    v_dot2_f32_bf16 v151, v191, v178, v151
    v_dot2_f32_bf16 v152, v184, v182, v152
    v_dot2_f32_bf16 v153, v185, v182, v153
    v_dot2_f32_bf16 v154, v186, v182, v154
    v_dot2_f32_bf16 v155, v187, v182, v155
    v_dot2_f32_bf16 v156, v188, v182, v156
    v_dot2_f32_bf16 v157, v189, v182, v157
    v_dot2_f32_bf16 v158, v190, v182, v158
    v_dot2_f32_bf16 v159, v191, v182, v159
    v_perm_b32 v184, v44, v40, s80
    v_perm_b32 v185, v44, v40, s81
    v_perm_b32 v186, v45, v41, s80
    v_perm_b32 v187, v45, v41, s81
    v_perm_b32 v188, v46, v42, s80
    v_perm_b32 v189, v46, v42, s81
    v_perm_b32 v190, v47, v43, s80
    v_perm_b32 v191, v47, v43, s81
    v_dot2_f32_bf16 v144, v184, v179, v144
    v_dot2_f32_bf16 v145, v185, v179, v145
    v_dot2_f32_bf16 v146, v186, v179, v146
    v_dot2_f32_bf16 v147, v187, v179, v147
    v_dot2_f32_bf16 v148, v188, v179, v148
    v_dot2_f32_bf16 v149, v189, v179, v149
    v_dot2_f32_bf16 v150, v190, v179, v150
    v_dot2_f32_bf16 v151, v191, v179, v151
    v_dot2_f32_bf16 v152, v184, v183, v152
    v_dot2_f32_bf16 v153, v185, v183, v153
    v_dot2_f32_bf16 v154, v186, v183, v154
    v_dot2_f32_bf16 v155, v187, v183, v155
    v_dot2_f32_bf16 v156, v188, v183, v156
    v_dot2_f32_bf16 v157, v189, v183, v157
    v_dot2_f32_bf16 v158, v190, v183, v158
    v_dot2_f32_bf16 v159, v191, v183, v159
    s_nop 3
    v_add_f32_dpp v144, v144, v144 row_ror:4 row_mask:0xf bank_mask:0xf
    v_add_f32_dpp v145, v145, v145 row_ror:4 row_mask:0xf bank_mask:0xf
    v_add_f32_dpp v146, v146, v146 row_ror:4 row_mask:0xf bank_mask:0xf
    v_add_f32_dpp v147, v147, v147 row_ror:4 row_mask:0xf bank_mask:0xf
    v_add_f32_dpp v148, v148, v148 row_ror:4 row_mask:0xf bank_mask:0xf
    v_add_f32_dpp v149, v149, v149 row_ror:4 row_mask:0xf bank_mask:0xf
    v_add_f32_dpp v150, v150, v150 row_ror:4 row_mask:0xf bank_mask:0xf
    v_add_f32_dpp v151, v151, v151 row_ror:4 row_mask:0xf bank_mask:0xf
    v_add_f32_dpp v152, v152, v152 row_ror:4 row_mask:0xf bank_mask:0xf
    v_add_f32_dpp v153, v153, v153 row_ror:4 row_mask:0xf bank_mask:0xf
    v_add_f32_dpp v154, v154, v154 row_ror:4 row_mask:0xf bank_mask:0xf
    v_add_f32_dpp v155, v155, v155 row_ror:4 row_mask:0xf bank_mask:0xf
    v_add_f32_dpp v156, v156, v156 row_ror:4 row_mask:0xf bank_mask:0xf
    v_add_f32_dpp v157, v157, v157 row_ror:4 row_mask:0xf bank_mask:0xf
    v_add_f32_dpp v158, v158, v158 row_ror:4 row_mask:0xf bank_mask:0xf
    v_add_f32_dpp v159, v159, v159 row_ror:4 row_mask:0xf bank_mask:0xf
    v_add_f32_dpp v144, v144, v144 row_ror:8 row_mask:0xf bank_mask:0xf
    v_add_f32_dpp v145, v145, v145 row_ror:8 row_mask:0xf bank_mask:0xf
    v_add_f32_dpp v146, v146, v146 row_ror:8 row_mask:0xf bank_mask:0xf
    v_add_f32_dpp v147, v147, v147 row_ror:8 row_mask:0xf bank_mask:0xf
    v_add_f32_dpp v148, v148, v148 row_ror:8 row_mask:0xf bank_mask:0xf
    v_add_f32_dpp v149, v149, v149 row_ror:8 row_mask:0xf bank_mask:0xf
    v_add_f32_dpp v150, v150, v150 row_ror:8 row_mask:0xf bank_mask:0xf
    v_add_f32_dpp v151, v151, v151 row_ror:8 row_mask:0xf bank_mask:0xf
    v_add_f32_dpp v152, v152, v152 row_ror:8 row_mask:0xf bank_mask:0xf
    v_add_f32_dpp v153, v153, v153 row_ror:8 row_mask:0xf bank_mask:0xf
    v_add_f32_dpp v154, v154, v154 row_ror:8 row_mask:0xf bank_mask:0xf
    v_add_f32_dpp v155, v155, v155 row_ror:8 row_mask:0xf bank_mask:0xf
    v_add_f32_dpp v156, v156, v156 row_ror:8 row_mask:0xf bank_mask:0xf
    v_add_f32_dpp v157, v157, v157 row_ror:8 row_mask:0xf bank_mask:0xf
    v_add_f32_dpp v158, v158, v158 row_ror:8 row_mask:0xf bank_mask:0xf
    v_add_f32_dpp v159, v159, v159 row_ror:8 row_mask:0xf bank_mask:0xf
    s_nop 1
    v_permlane16_swap_b32 v144, v145
    v_permlane16_swap_b32 v146, v147
    v_permlane16_swap_b32 v148, v149
    v_permlane16_swap_b32 v150, v151
    v_permlane16_swap_b32 v152, v153
    v_permlane16_swap_b32 v154, v155
    v_permlane16_swap_b32 v156, v157
    v_permlane16_swap_b32 v158, v159
    s_nop 1
    v_add_f32 v144, v144, v145
    v_add_f32 v146, v146, v147
    v_add_f32 v148, v148, v149
    v_add_f32 v150, v150, v151
    v_add_f32 v152, v152, v153
    v_add_f32 v154, v154, v155
    v_add_f32 v156, v156, v157
    v_add_f32 v158, v158, v159
    s_nop 1
    v_permlane32_swap_b32 v144, v146
    v_permlane32_swap_b32 v148, v150
    v_permlane32_swap_b32 v152, v154
    v_permlane32_swap_b32 v156, v158
    s_nop 1
    v_add_f32 v144, v144, v146
    v_add_f32 v148, v148, v150
    v_add_f32 v152, v152, v154
    v_add_f32 v156, v156, v158
    s_lshl_b32 s88, s14, 10
    v_lshlrev_b32 v11, 2, v2
    v_add_u32 v11, s88, v11
    ds_write_b32 v11, v144 offset:0
    ds_write_b32 v11, v148 offset:256
    ds_write_b32 v11, v152 offset:512
    ds_write_b32 v11, v156 offset:768
    s_waitcnt lgkmcnt(0)
    s_barrier
    s_add_u32 s10, s12, 0
    s_lshl_b32 s10, s10, 13
    s_add_u32 s11, s10, 4096
    buffer_load_dwordx4 v[16:19], v5, s[44:47], s10 offen offset:0 nt
    buffer_load_dwordx4 v[20:23], v5, s[44:47], s10 offen offset:256 nt
    buffer_load_dwordx4 v[24:27], v5, s[44:47], s10 offen offset:2048 nt
    buffer_load_dwordx4 v[28:31], v5, s[44:47], s10 offen offset:2304 nt
    buffer_load_dwordx4 v[32:35], v5, s[44:47], s11 offen offset:0 nt
    buffer_load_dwordx4 v[36:39], v5, s[44:47], s11 offen offset:256 nt
    buffer_load_dwordx4 v[40:43], v5, s[44:47], s11 offen offset:2048 nt
    buffer_load_dwordx4 v[44:47], v5, s[44:47], s11 offen offset:2304 nt
    s_add_u32 s10, s12, 8
    s_lshl_b32 s10, s10, 13
    s_add_u32 s11, s10, 4096
    buffer_load_dwordx4 v[48:51], v5, s[44:47], s10 offen offset:0 nt
    buffer_load_dwordx4 v[52:55], v5, s[44:47], s10 offen offset:256 nt
    buffer_load_dwordx4 v[56:59], v5, s[44:47], s10 offen offset:2048 nt
    buffer_load_dwordx4 v[60:63], v5, s[44:47], s10 offen offset:2304 nt
    buffer_load_dwordx4 v[64:67], v5, s[44:47], s11 offen offset:0 nt
    buffer_load_dwordx4 v[68:71], v5, s[44:47], s11 offen offset:256 nt
    buffer_load_dwordx4 v[72:75], v5, s[44:47], s11 offen offset:2048 nt
    buffer_load_dwordx4 v[76:79], v5, s[44:47], s11 offen offset:2304 nt
    s_add_u32 s10, s12, 16
    s_lshl_b32 s10, s10, 13
    s_add_u32 s11, s10, 4096
    buffer_load_dwordx4 v[80:83], v5, s[44:47], s10 offen offset:0 nt
    buffer_load_dwordx4 v[84:87], v5, s[44:47], s10 offen offset:256 nt
    buffer_load_dwordx4 v[88:91], v5, s[44:47], s10 offen offset:2048 nt
    buffer_load_dwordx4 v[92:95], v5, s[44:47], s10 offen offset:2304 nt
    buffer_load_dwordx4 v[96:99], v5, s[44:47], s11 offen offset:0 nt
    buffer_load_dwordx4 v[100:103], v5, s[44:47], s11 offen offset:256 nt
    buffer_load_dwordx4 v[104:107], v5, s[44:47], s11 offen offset:2048 nt
    buffer_load_dwordx4 v[108:111], v5, s[44:47], s11 offen offset:2304 nt
    s_add_u32 s10, s12, 24
    s_lshl_b32 s10, s10, 13
    s_add_u32 s11, s10, 4096
    buffer_load_dwordx4 v[112:115], v5, s[44:47], s10 offen offset:0 nt
    buffer_load_dwordx4 v[116:119], v5, s[44:47], s10 offen offset:256 nt
    buffer_load_dwordx4 v[120:123], v5, s[44:47], s10 offen offset:2048 nt
    buffer_load_dwordx4 v[124:127], v5, s[44:47], s10 offen offset:2304 nt
    buffer_load_dwordx4 v[128:131], v5, s[44:47], s11 offen offset:0 nt
    buffer_load_dwordx4 v[132:135], v5, s[44:47], s11 offen offset:256 nt
    buffer_load_dwordx4 v[136:139], v5, s[44:47], s11 offen offset:2048 nt
    buffer_load_dwordx4 v[140:143], v5, s[44:47], s11 offen offset:2304 nt
L_qwait:
    v_mov_b32 v11, 5264
L_qspin:
    ds_read_b32 v12, v11
    s_waitcnt lgkmcnt(0)
    v_readfirstlane_b32 s13, v12
    s_cmp_lg_u32 s13, 0
    s_cbranch_scc1 L_main
    s_sleep 1
    s_branch L_qspin
L_helper:
    v_lshlrev_b32 v11, 4, v2
    buffer_load_dwordx4 v[176:179], v11, s[64:67], 0 offen
    buffer_load_dwordx4 v[180:183], v11, s[64:67], 0 offen offset:896
    buffer_load_dwordx4 v[160:163], v11, s[68:71], 0 offen
    v_mov_b32 v12, 5264
    v_mov_b32 v13, 0
    ds_write_b32 v12, v13
    v_mov_b32 v13, 0
    ds_write_b32 v12, v13 offset:4
    s_waitcnt lgkmcnt(0)
    s_barrier
    s_waitcnt vmcnt(0)
    v_mov_b32 v12, 0
    v_mov_b32 v13, 0
    v_dot2_f32_bf16 v12, v176, v160, v12
    v_dot2_f32_bf16 v13, v180, v160, v13
    v_dot2_f32_bf16 v12, v177, v161, v12
    v_dot2_f32_bf16 v13, v181, v161, v13
    v_dot2_f32_bf16 v12, v178, v162, v12
    v_dot2_f32_bf16 v13, v182, v162, v13
    v_dot2_f32_bf16 v12, v179, v163, v12
    v_dot2_f32_bf16 v13, v183, v163, v13
    s_nop 3
    v_add_f32_dpp v12, v12, v12 quad_perm:[1,0,3,2] row_mask:0xf bank_mask:0xf
    v_add_f32_dpp v13, v13, v13 quad_perm:[1,0,3,2] row_mask:0xf bank_mask:0xf
    s_nop 1
    v_add_f32_dpp v12, v12, v12 quad_perm:[2,3,0,1] row_mask:0xf bank_mask:0xf
    v_add_f32_dpp v13, v13, v13 quad_perm:[2,3,0,1] row_mask:0xf bank_mask:0xf
    s_nop 1
    v_add_f32_dpp v12, v12, v12 row_half_mirror row_mask:0xf bank_mask:0xf
    v_add_f32_dpp v13, v13, v13 row_half_mirror row_mask:0xf bank_mask:0xf
    s_nop 1
    v_add_f32_dpp v12, v12, v12 row_mirror row_mask:0xf bank_mask:0xf
    v_add_f32_dpp v13, v13, v13 row_mirror row_mask:0xf bank_mask:0xf
    s_nop 1
    v_mov_b32 v14, v12
    v_mov_b32 v15, v13
    s_nop 1
    v_permlane16_swap_b32 v12, v14
    v_permlane16_swap_b32 v13, v15
    s_nop 1
    v_add_f32 v12, v12, v14
    v_add_f32 v13, v13, v15
    s_nop 1
    v_mov_b32 v14, v12
    v_mov_b32 v15, v13
    s_nop 1
    v_permlane32_swap_b32 v12, v14
    v_permlane32_swap_b32 v13, v15
    s_nop 1
    v_add_f32 v12, v12, v14
    v_add_f32 v13, v13, v15
    s_nop 1
    s_mov_b32 s15, 0xbfb8aa3b
    s_mov_b32 s88, 0x3fb8aa3b
    s_cmp_eq_u32 s7, 0
    s_cselect_b32 s15, s15, s88
    v_mul_f32 v12, s15, v12
    v_mul_f32 v13, s15, v13
    v_exp_f32 v12, v12
    v_exp_f32 v13, v13
    s_nop 0
    v_add_f32 v12, 1.0, v12
    v_add_f32 v13, 1.0, v13
    v_rcp_f32 v12, v12
    v_rcp_f32 v13, v13
    v_mov_b32 v11, 5248
    ds_write_b64 v11, v[12:13]
    v_lshrrev_b32 v11, 5, v2
    v_lshlrev_b32 v11, 9, v11
    v_bfe_u32 v12, v2, 2, 1
    v_lshlrev_b32 v12, 8, v12
    v_and_b32 v13, 3, v2
    v_lshlrev_b32 v13, 6, v13
    v_add3_u32 v11, v11, v12, v13
    v_bfe_u32 v12, v2, 3, 2
    v_lshlrev_b32 v12, 2, v12
    v_add_u32 v11, v11, v12
    v_lshrrev_b32 v14, 5, v2
    v_lshlrev_b32 v14, 11, v14
    v_and_b32 v12, 31, v2
    v_lshlrev_b32 v12, 2, v12
    v_add_u32 v14, v14, v12
    v_lshlrev_b32 v15, 5, v2
    s_lshl_b32 s15, s3, 12
    s_lshl_b32 s88, s86, 7
    s_add_u32 s15, s15, s88
    s_lshl_b32 s14, s3, 12
    s_lshl_b32 s88, s5, 11
    s_add_u32 s14, s14, s88
    s_mov_b32 s90, 0x55555555
    s_mov_b32 s91, 0x55555555
    v_bfe_u32 v12, v2, 1, 1
    v_mul_lo_u32 v12, v12, s83
    s_and_b32 s88, s92, -2
    s_or_b32 s88, s88, s87
    v_xor_b32 v221, s88, v12
    s_sub_u32 s101, s92, 3000
    s_waitcnt lgkmcnt(0)
    s_barrier
    ds_read_b32 v216, v11 offset:0
    ds_read_b32 v217, v11 offset:1024
    ds_read_b32 v218, v11 offset:2048
    ds_read_b32 v219, v11 offset:3072
    s_waitcnt lgkmcnt(0)
    v_add_f32 v216, v216, v217
    v_add_f32 v218, v218, v219
    v_add_f32 v216, v216, v218
    s_nop 1
    v_mov_b32_dpp v217, v216 quad_perm:[1,1,3,3] row_mask:0xf bank_mask:0xf
    s_nop 0
    v_cvt_pk_bf16_f32 v220, v216, v217
    s_mov_b64 exec, s[90:91]
    buffer_store_dwordx2 v[220:221], v14, s[60:63], s15 offen offset:0 sc1
    s_mov_b64 exec, -1
    s_sleep 8
    buffer_load_dwordx4 v[208:211], v15, s[60:63], s14 offen offset:0 sc1
    buffer_load_dwordx4 v[212:215], v15, s[60:63], s14 offen offset:16 sc1
    s_sleep 16
    buffer_load_dwordx4 v[144:147], v15, s[60:63], s14 offen offset:0 sc1
    buffer_load_dwordx4 v[148:151], v15, s[60:63], s14 offen offset:16 sc1
    s_sleep 16
    buffer_load_dwordx4 v[152:155], v15, s[60:63], s14 offen offset:0 sc1
    buffer_load_dwordx4 v[156:159], v15, s[60:63], s14 offen offset:16 sc1
    s_waitcnt vmcnt(4)
    v_xor_b32 v12, v209, v211
    v_xor_b32 v12, s83, v12
    v_subrev_u32 v209, s101, v209
    v_lshrrev_b32 v209, 24, v209
    v_or_b32 v11, v12, v209
    v_xor_b32 v12, v213, v215
    v_xor_b32 v12, s83, v12
    v_subrev_u32 v213, s101, v213
    v_lshrrev_b32 v213, 24, v213
    v_or3_b32 v11, v11, v12, v213
    v_cmp_ne_u32 vcc, 0, v11
    s_cbranch_vccz L_qgot
    s_waitcnt vmcnt(2)
    v_xor_b32 v12, v145, v147
    v_xor_b32 v12, s83, v12
    v_subrev_u32 v145, s101, v145
    v_lshrrev_b32 v145, 24, v145
    v_or_b32 v11, v12, v145
    v_xor_b32 v12, v149, v151
    v_xor_b32 v12, s83, v12
    v_subrev_u32 v149, s101, v149
    v_lshrrev_b32 v149, 24, v149
    v_or3_b32 v11, v11, v12, v149
    v_cmp_ne_u32 vcc, 0, v11
    s_cbranch_vccz L_qgotB
    s_waitcnt vmcnt(0)
    v_xor_b32 v12, v153, v155
    v_xor_b32 v12, s83, v12
    v_subrev_u32 v153, s101, v153
    v_lshrrev_b32 v153, 24, v153
    v_or_b32 v11, v12, v153
    v_xor_b32 v12, v157, v159
    v_xor_b32 v12, s83, v12
    v_subrev_u32 v157, s101, v157
    v_lshrrev_b32 v157, 24, v157
    v_or3_b32 v11, v11, v12, v157
    v_cmp_ne_u32 vcc, 0, v11
    s_cbranch_vccz L_qgotC
    s_mov_b32 s89, 0
L_qpoll:
    buffer_load_dwordx4 v[208:211], v15, s[60:63], s14 offen offset:0 sc1
    buffer_load_dwordx4 v[212:215], v15, s[60:63], s14 offen offset:16 sc1
    s_waitcnt vmcnt(0)
    v_xor_b32 v12, v209, v211
    v_xor_b32 v12, s83, v12
    v_subrev_u32 v209, s101, v209
    v_lshrrev_b32 v209, 24, v209
    v_or_b32 v11, v12, v209
    v_xor_b32 v12, v213, v215
    v_xor_b32 v12, s83, v12
    v_subrev_u32 v213, s101, v213
    v_lshrrev_b32 v213, 24, v213
    v_or3_b32 v11, v11, v12, v213
    v_cmp_ne_u32 vcc, 0, v11
    s_cbranch_vccz L_qgot
    s_add_u32 s89, s89, 1
    s_cmp_lt_u32 s89, 400000
    s_cbranch_scc1 L_qpoll
    s_branch L_qgot
L_qgotB:
    v_mov_b32 v208, v144
    v_mov_b32 v209, v145
    v_mov_b32 v210, v146
    v_mov_b32 v211, v147
    v_mov_b32 v212, v148
    v_mov_b32 v213, v149
    v_mov_b32 v214, v150
    v_mov_b32 v215, v151
    s_branch L_qgot
L_qgotC:
    v_mov_b32 v208, v152
    v_mov_b32 v209, v153
    v_mov_b32 v210, v154
    v_mov_b32 v211, v155
    v_mov_b32 v212, v156
    v_mov_b32 v213, v157
    v_mov_b32 v214, v158
    v_mov_b32 v215, v159
L_qgot:
    s_xor_b32 s15, s86, 8
    s_lshl_b32 s15, s15, 2
    s_nop 3
    v_readlane_b32 s88, v211, s15
    s_xor_b32 s88, s88, s83
    s_and_b32 s88, s88, 1
    s_sub_u32 s88, s88, s87
    s_mul_i32 s88, s88, 4
    s_add_u32 s13, s88, 64
    v_mov_b32 v209, v210
    v_mov_b32 v210, v212
    v_mov_b32 v211, v214
    v_lshlrev_b32 v11, 4, v2
    ds_write_b128 v11, v[208:211] offset:4096
    v_mov_b32 v11, 5248
    v_mov_b32 v13, s13
    s_waitcnt lgkmcnt(0)
    ds_write_b32 v11, v13 offset:16
    s_waitcnt vmcnt(0)
    s_add_u32 s10, s12, 0
    s_lshl_b32 s10, s10, 13
    s_add_u32 s11, s10, 4096
    buffer_load_dwordx4 v[16:19], v5, s[44:47], s10 offen offset:0 nt
    buffer_load_dwordx4 v[20:23], v5, s[44:47], s10 offen offset:256 nt
    buffer_load_dwordx4 v[24:27], v5, s[44:47], s10 offen offset:2048 nt
    buffer_load_dwordx4 v[28:31], v5, s[44:47], s10 offen offset:2304 nt
    buffer_load_dwordx4 v[32:35], v5, s[44:47], s11 offen offset:0 nt
    buffer_load_dwordx4 v[36:39], v5, s[44:47], s11 offen offset:256 nt
    buffer_load_dwordx4 v[40:43], v5, s[44:47], s11 offen offset:2048 nt
    buffer_load_dwordx4 v[44:47], v5, s[44:47], s11 offen offset:2304 nt
    s_add_u32 s10, s12, 8
    s_lshl_b32 s10, s10, 13
    s_add_u32 s11, s10, 4096
    buffer_load_dwordx4 v[48:51], v5, s[44:47], s10 offen offset:0 nt
    buffer_load_dwordx4 v[52:55], v5, s[44:47], s10 offen offset:256 nt
    buffer_load_dwordx4 v[56:59], v5, s[44:47], s10 offen offset:2048 nt
    buffer_load_dwordx4 v[60:63], v5, s[44:47], s10 offen offset:2304 nt
    buffer_load_dwordx4 v[64:67], v5, s[44:47], s11 offen offset:0 nt
    buffer_load_dwordx4 v[68:71], v5, s[44:47], s11 offen offset:256 nt
    buffer_load_dwordx4 v[72:75], v5, s[44:47], s11 offen offset:2048 nt
    buffer_load_dwordx4 v[76:79], v5, s[44:47], s11 offen offset:2304 nt
    s_add_u32 s10, s12, 16
    s_lshl_b32 s10, s10, 13
    s_add_u32 s11, s10, 4096
    buffer_load_dwordx4 v[80:83], v5, s[44:47], s10 offen offset:0 nt
    buffer_load_dwordx4 v[84:87], v5, s[44:47], s10 offen offset:256 nt
    buffer_load_dwordx4 v[88:91], v5, s[44:47], s10 offen offset:2048 nt
    buffer_load_dwordx4 v[92:95], v5, s[44:47], s10 offen offset:2304 nt
    buffer_load_dwordx4 v[96:99], v5, s[44:47], s11 offen offset:0 nt
    buffer_load_dwordx4 v[100:103], v5, s[44:47], s11 offen offset:256 nt
    buffer_load_dwordx4 v[104:107], v5, s[44:47], s11 offen offset:2048 nt
    buffer_load_dwordx4 v[108:111], v5, s[44:47], s11 offen offset:2304 nt
    s_add_u32 s10, s12, 24
    s_lshl_b32 s10, s10, 13
    s_add_u32 s11, s10, 4096
    buffer_load_dwordx4 v[112:115], v5, s[44:47], s10 offen offset:0 nt
    buffer_load_dwordx4 v[116:119], v5, s[44:47], s10 offen offset:256 nt
    buffer_load_dwordx4 v[120:123], v5, s[44:47], s10 offen offset:2048 nt
    buffer_load_dwordx4 v[124:127], v5, s[44:47], s10 offen offset:2304 nt
    buffer_load_dwordx4 v[128:131], v5, s[44:47], s11 offen offset:0 nt
    buffer_load_dwordx4 v[132:135], v5, s[44:47], s11 offen offset:256 nt
    buffer_load_dwordx4 v[136:139], v5, s[44:47], s11 offen offset:2048 nt
    buffer_load_dwordx4 v[140:143], v5, s[44:47], s11 offen offset:2304 nt
L_main:
    v_and_b32 v11, 1, v3
    v_lshlrev_b32 v11, 9, v11
    v_bfe_u32 v12, v3, 1, 2
    v_lshlrev_b32 v12, 4, v12
    v_lshlrev_b32 v13, 6, v4
    v_add3_u32 v11, v11, v12, v13
    ds_read_b128 v[208:211], v11 offset:4096
    ds_read_b128 v[212:215], v11 offset:4352
    s_and_b32 s15, s6, 1
    s_mul_i32 s15, s15, s13
    s_sub_u32 s100, s12, s15
    s_add_u32 s15, s9, 56
    s_cmp_lt_u32 s15, s13
    s_cselect_b32 s40, 0, 0xff7fffff
    s_add_u32 s15, s9, 64
    s_cmp_lt_u32 s15, s13
    s_cselect_b32 s41, 0, 0xff7fffff
    s_waitcnt lgkmcnt(0)
    s_waitcnt vmcnt(31)
    v_mfma_f32_16x16x32_bf16 v[144:147], v[16:19], v[208:211], 0
    s_add_u32 s10, s100, 32
    s_lshl_b32 s10, s10, 13
    s_add_u32 s11, s10, 4096
    buffer_load_dwordx4 v[16:19], v5, s[44:47], s10 offen offset:0 nt
    s_waitcnt vmcnt(31)
    v_mfma_f32_16x16x32_bf16 v[144:147], v[20:23], v[212:215], v[144:147]
    buffer_load_dwordx4 v[20:23], v5, s[44:47], s10 offen offset:256 nt
    s_waitcnt vmcnt(31)
    v_mfma_f32_16x16x32_bf16 v[148:151], v[24:27], v[208:211], 0
    buffer_load_dwordx4 v[24:27], v5, s[44:47], s10 offen offset:2048 nt
    s_waitcnt vmcnt(31)
    v_mfma_f32_16x16x32_bf16 v[148:151], v[28:31], v[212:215], v[148:151]
    buffer_load_dwordx4 v[28:31], v5, s[44:47], s10 offen offset:2304 nt
    s_waitcnt vmcnt(31)
    v_mfma_f32_16x16x32_bf16 v[152:155], v[32:35], v[208:211], 0
    buffer_load_dwordx4 v[32:35], v5, s[44:47], s11 offen offset:0 nt
    s_waitcnt vmcnt(31)
    v_mfma_f32_16x16x32_bf16 v[152:155], v[36:39], v[212:215], v[152:155]
    buffer_load_dwordx4 v[36:39], v5, s[44:47], s11 offen offset:256 nt
    s_waitcnt vmcnt(31)
    v_mfma_f32_16x16x32_bf16 v[156:159], v[40:43], v[208:211], 0
    buffer_load_dwordx4 v[40:43], v5, s[44:47], s11 offen offset:2048 nt
    s_waitcnt vmcnt(31)
    v_mfma_f32_16x16x32_bf16 v[156:159], v[44:47], v[212:215], v[156:159]
    buffer_load_dwordx4 v[44:47], v5, s[44:47], s11 offen offset:2304 nt
    v_add_f32_dpp v184, v145, v144 row_shl:2 row_mask:0xf bank_mask:0xf bound_ctrl:0
    v_add_f32_dpp v185, v147, v146 row_shl:2 row_mask:0xf bank_mask:0xf bound_ctrl:0
    v_add_f32_dpp v186, v149, v148 row_shl:2 row_mask:0xf bank_mask:0xf bound_ctrl:0
    v_add_f32_dpp v187, v151, v150 row_shl:2 row_mask:0xf bank_mask:0xf bound_ctrl:0
    v_add_f32_dpp v188, v153, v152 row_shl:2 row_mask:0xf bank_mask:0xf bound_ctrl:0
    v_add_f32_dpp v189, v155, v154 row_shl:2 row_mask:0xf bank_mask:0xf bound_ctrl:0
    s_nop 3
    v_add_f32_dpp v190, v157, v156 row_shl:2 row_mask:0xf bank_mask:0xf bound_ctrl:0
    v_add_f32_dpp v191, v159, v158 row_shl:2 row_mask:0xf bank_mask:0xf bound_ctrl:0
    v_add_f32_dpp v216, v185, v184 row_shl:4 row_mask:0xf bank_mask:0xf bound_ctrl:0
    v_add_f32_dpp v217, v187, v186 row_shl:4 row_mask:0xf bank_mask:0xf bound_ctrl:0
    v_add_f32_dpp v218, v189, v188 row_shl:4 row_mask:0xf bank_mask:0xf bound_ctrl:0
    v_add_f32_dpp v219, v191, v190 row_shl:4 row_mask:0xf bank_mask:0xf bound_ctrl:0
    s_waitcnt vmcnt(31)
    v_mfma_f32_16x16x32_bf16 v[144:147], v[48:51], v[208:211], 0
    s_add_u32 s10, s100, 40
    s_lshl_b32 s10, s10, 13
    s_add_u32 s11, s10, 4096
    buffer_load_dwordx4 v[48:51], v5, s[44:47], s10 offen offset:0 nt
    s_waitcnt vmcnt(31)
    v_mfma_f32_16x16x32_bf16 v[144:147], v[52:55], v[212:215], v[144:147]
    buffer_load_dwordx4 v[52:55], v5, s[44:47], s10 offen offset:256 nt
    s_waitcnt vmcnt(31)
    v_mfma_f32_16x16x32_bf16 v[148:151], v[56:59], v[208:211], 0
    buffer_load_dwordx4 v[56:59], v5, s[44:47], s10 offen offset:2048 nt
    s_waitcnt vmcnt(31)
    v_mfma_f32_16x16x32_bf16 v[148:151], v[60:63], v[212:215], v[148:151]
    buffer_load_dwordx4 v[60:63], v5, s[44:47], s10 offen offset:2304 nt
    s_waitcnt vmcnt(31)
    v_mfma_f32_16x16x32_bf16 v[152:155], v[64:67], v[208:211], 0
    buffer_load_dwordx4 v[64:67], v5, s[44:47], s11 offen offset:0 nt
    s_waitcnt vmcnt(31)
    v_mfma_f32_16x16x32_bf16 v[152:155], v[68:71], v[212:215], v[152:155]
    buffer_load_dwordx4 v[68:71], v5, s[44:47], s11 offen offset:256 nt
    s_waitcnt vmcnt(31)
    v_mfma_f32_16x16x32_bf16 v[156:159], v[72:75], v[208:211], 0
    buffer_load_dwordx4 v[72:75], v5, s[44:47], s11 offen offset:2048 nt
    s_waitcnt vmcnt(31)
    v_mfma_f32_16x16x32_bf16 v[156:159], v[76:79], v[212:215], v[156:159]
    buffer_load_dwordx4 v[76:79], v5, s[44:47], s11 offen offset:2304 nt
    v_add_f32_dpp v184, v145, v144 row_shl:2 row_mask:0xf bank_mask:0xf bound_ctrl:0
    v_add_f32_dpp v185, v147, v146 row_shl:2 row_mask:0xf bank_mask:0xf bound_ctrl:0
    v_add_f32_dpp v186, v149, v148 row_shl:2 row_mask:0xf bank_mask:0xf bound_ctrl:0
    v_add_f32_dpp v187, v151, v150 row_shl:2 row_mask:0xf bank_mask:0xf bound_ctrl:0
    v_add_f32_dpp v188, v153, v152 row_shl:2 row_mask:0xf bank_mask:0xf bound_ctrl:0
    v_add_f32_dpp v189, v155, v154 row_shl:2 row_mask:0xf bank_mask:0xf bound_ctrl:0
    s_nop 3
    v_add_f32_dpp v190, v157, v156 row_shl:2 row_mask:0xf bank_mask:0xf bound_ctrl:0
    v_add_f32_dpp v191, v159, v158 row_shl:2 row_mask:0xf bank_mask:0xf bound_ctrl:0
    v_add_f32_dpp v220, v185, v184 row_shl:4 row_mask:0xf bank_mask:0xf bound_ctrl:0
    v_add_f32_dpp v221, v187, v186 row_shl:4 row_mask:0xf bank_mask:0xf bound_ctrl:0
    v_add_f32_dpp v222, v189, v188 row_shl:4 row_mask:0xf bank_mask:0xf bound_ctrl:0
    v_add_f32_dpp v223, v191, v190 row_shl:4 row_mask:0xf bank_mask:0xf bound_ctrl:0
    s_waitcnt vmcnt(31)
    v_mfma_f32_16x16x32_bf16 v[144:147], v[80:83], v[208:211], 0
    s_add_u32 s10, s100, 48
    s_lshl_b32 s10, s10, 13
    s_add_u32 s11, s10, 4096
    buffer_load_dwordx4 v[80:83], v5, s[44:47], s10 offen offset:0 nt
    s_waitcnt vmcnt(31)
    v_mfma_f32_16x16x32_bf16 v[144:147], v[84:87], v[212:215], v[144:147]
    buffer_load_dwordx4 v[84:87], v5, s[44:47], s10 offen offset:256 nt
    s_waitcnt vmcnt(31)
    v_mfma_f32_16x16x32_bf16 v[148:151], v[88:91], v[208:211], 0
    buffer_load_dwordx4 v[88:91], v5, s[44:47], s10 offen offset:2048 nt
    s_waitcnt vmcnt(31)
    v_mfma_f32_16x16x32_bf16 v[148:151], v[92:95], v[212:215], v[148:151]
    buffer_load_dwordx4 v[92:95], v5, s[44:47], s10 offen offset:2304 nt
    s_waitcnt vmcnt(31)
    v_mfma_f32_16x16x32_bf16 v[152:155], v[96:99], v[208:211], 0
    buffer_load_dwordx4 v[96:99], v5, s[44:47], s11 offen offset:0 nt
    s_waitcnt vmcnt(31)
    v_mfma_f32_16x16x32_bf16 v[152:155], v[100:103], v[212:215], v[152:155]
    buffer_load_dwordx4 v[100:103], v5, s[44:47], s11 offen offset:256 nt
    s_waitcnt vmcnt(31)
    v_mfma_f32_16x16x32_bf16 v[156:159], v[104:107], v[208:211], 0
    buffer_load_dwordx4 v[104:107], v5, s[44:47], s11 offen offset:2048 nt
    s_waitcnt vmcnt(31)
    v_mfma_f32_16x16x32_bf16 v[156:159], v[108:111], v[212:215], v[156:159]
    buffer_load_dwordx4 v[108:111], v5, s[44:47], s11 offen offset:2304 nt
    v_add_f32_dpp v184, v145, v144 row_shl:2 row_mask:0xf bank_mask:0xf bound_ctrl:0
    v_add_f32_dpp v185, v147, v146 row_shl:2 row_mask:0xf bank_mask:0xf bound_ctrl:0
    v_add_f32_dpp v186, v149, v148 row_shl:2 row_mask:0xf bank_mask:0xf bound_ctrl:0
    v_add_f32_dpp v187, v151, v150 row_shl:2 row_mask:0xf bank_mask:0xf bound_ctrl:0
    v_add_f32_dpp v188, v153, v152 row_shl:2 row_mask:0xf bank_mask:0xf bound_ctrl:0
    v_add_f32_dpp v189, v155, v154 row_shl:2 row_mask:0xf bank_mask:0xf bound_ctrl:0
    s_nop 3
    v_add_f32_dpp v190, v157, v156 row_shl:2 row_mask:0xf bank_mask:0xf bound_ctrl:0
    v_add_f32_dpp v191, v159, v158 row_shl:2 row_mask:0xf bank_mask:0xf bound_ctrl:0
    v_add_f32_dpp v224, v185, v184 row_shl:4 row_mask:0xf bank_mask:0xf bound_ctrl:0
    v_add_f32_dpp v225, v187, v186 row_shl:4 row_mask:0xf bank_mask:0xf bound_ctrl:0
    v_add_f32_dpp v226, v189, v188 row_shl:4 row_mask:0xf bank_mask:0xf bound_ctrl:0
    v_add_f32_dpp v227, v191, v190 row_shl:4 row_mask:0xf bank_mask:0xf bound_ctrl:0
    s_waitcnt vmcnt(31)
    v_mfma_f32_16x16x32_bf16 v[144:147], v[112:115], v[208:211], 0
    s_add_u32 s10, s100, 56
    s_lshl_b32 s10, s10, 13
    s_add_u32 s11, s9, 56
    s_cmp_lt_u32 s11, s13
    s_cselect_b32 s10, s10, 0x400000
    s_add_u32 s11, s10, 4096
    buffer_load_dwordx4 v[112:115], v5, s[44:47], s10 offen offset:0 nt
    s_waitcnt vmcnt(31)
    v_mfma_f32_16x16x32_bf16 v[144:147], v[116:119], v[212:215], v[144:147]
    buffer_load_dwordx4 v[116:119], v5, s[44:47], s10 offen offset:256 nt
    s_waitcnt vmcnt(31)
    v_mfma_f32_16x16x32_bf16 v[148:151], v[120:123], v[208:211], 0
    buffer_load_dwordx4 v[120:123], v5, s[44:47], s10 offen offset:2048 nt
    s_waitcnt vmcnt(31)
    v_mfma_f32_16x16x32_bf16 v[148:151], v[124:127], v[212:215], v[148:151]
    buffer_load_dwordx4 v[124:127], v5, s[44:47], s10 offen offset:2304 nt
    s_waitcnt vmcnt(31)
    v_mfma_f32_16x16x32_bf16 v[152:155], v[128:131], v[208:211], 0
    buffer_load_dwordx4 v[128:131], v5, s[44:47], s11 offen offset:0 nt
    s_waitcnt vmcnt(31)
    v_mfma_f32_16x16x32_bf16 v[152:155], v[132:135], v[212:215], v[152:155]
    buffer_load_dwordx4 v[132:135], v5, s[44:47], s11 offen offset:256 nt
    s_waitcnt vmcnt(31)
    v_mfma_f32_16x16x32_bf16 v[156:159], v[136:139], v[208:211], 0
    buffer_load_dwordx4 v[136:139], v5, s[44:47], s11 offen offset:2048 nt
    s_waitcnt vmcnt(31)
    v_mfma_f32_16x16x32_bf16 v[156:159], v[140:143], v[212:215], v[156:159]
    buffer_load_dwordx4 v[140:143], v5, s[44:47], s11 offen offset:2304 nt
    v_add_f32_dpp v184, v145, v144 row_shl:2 row_mask:0xf bank_mask:0xf bound_ctrl:0
    v_add_f32_dpp v185, v147, v146 row_shl:2 row_mask:0xf bank_mask:0xf bound_ctrl:0
    v_add_f32_dpp v186, v149, v148 row_shl:2 row_mask:0xf bank_mask:0xf bound_ctrl:0
    v_add_f32_dpp v187, v151, v150 row_shl:2 row_mask:0xf bank_mask:0xf bound_ctrl:0
    v_add_f32_dpp v188, v153, v152 row_shl:2 row_mask:0xf bank_mask:0xf bound_ctrl:0
    v_add_f32_dpp v189, v155, v154 row_shl:2 row_mask:0xf bank_mask:0xf bound_ctrl:0
    s_nop 3
    v_add_f32_dpp v190, v157, v156 row_shl:2 row_mask:0xf bank_mask:0xf bound_ctrl:0
    v_add_f32_dpp v191, v159, v158 row_shl:2 row_mask:0xf bank_mask:0xf bound_ctrl:0
    v_add_f32_dpp v228, v185, v184 row_shl:4 row_mask:0xf bank_mask:0xf bound_ctrl:0
    v_add_f32_dpp v229, v187, v186 row_shl:4 row_mask:0xf bank_mask:0xf bound_ctrl:0
    v_add_f32_dpp v230, v189, v188 row_shl:4 row_mask:0xf bank_mask:0xf bound_ctrl:0
    v_add_f32_dpp v231, v191, v190 row_shl:4 row_mask:0xf bank_mask:0xf bound_ctrl:0
    s_waitcnt vmcnt(31)
    v_mfma_f32_16x16x32_bf16 v[144:147], v[16:19], v[208:211], 0
    s_add_u32 s10, s100, 64
    s_lshl_b32 s10, s10, 13
    s_add_u32 s11, s9, 64
    s_cmp_lt_u32 s11, s13
    s_cselect_b32 s10, s10, 0x400000
    s_add_u32 s11, s10, 4096
    buffer_load_dwordx4 v[16:19], v5, s[44:47], s10 offen offset:0 nt
    s_waitcnt vmcnt(31)
    v_mfma_f32_16x16x32_bf16 v[144:147], v[20:23], v[212:215], v[144:147]
    buffer_load_dwordx4 v[20:23], v5, s[44:47], s10 offen offset:256 nt
    s_waitcnt vmcnt(31)
    v_mfma_f32_16x16x32_bf16 v[148:151], v[24:27], v[208:211], 0
    buffer_load_dwordx4 v[24:27], v5, s[44:47], s10 offen offset:2048 nt
    s_waitcnt vmcnt(31)
    v_mfma_f32_16x16x32_bf16 v[148:151], v[28:31], v[212:215], v[148:151]
    buffer_load_dwordx4 v[28:31], v5, s[44:47], s10 offen offset:2304 nt
    s_waitcnt vmcnt(31)
    v_mfma_f32_16x16x32_bf16 v[152:155], v[32:35], v[208:211], 0
    buffer_load_dwordx4 v[32:35], v5, s[44:47], s11 offen offset:0 nt
    s_waitcnt vmcnt(31)
    v_mfma_f32_16x16x32_bf16 v[152:155], v[36:39], v[212:215], v[152:155]
    buffer_load_dwordx4 v[36:39], v5, s[44:47], s11 offen offset:256 nt
    s_waitcnt vmcnt(31)
    v_mfma_f32_16x16x32_bf16 v[156:159], v[40:43], v[208:211], 0
    buffer_load_dwordx4 v[40:43], v5, s[44:47], s11 offen offset:2048 nt
    s_waitcnt vmcnt(31)
    v_mfma_f32_16x16x32_bf16 v[156:159], v[44:47], v[212:215], v[156:159]
    buffer_load_dwordx4 v[44:47], v5, s[44:47], s11 offen offset:2304 nt
    v_add_f32_dpp v184, v145, v144 row_shl:2 row_mask:0xf bank_mask:0xf bound_ctrl:0
    v_add_f32_dpp v185, v147, v146 row_shl:2 row_mask:0xf bank_mask:0xf bound_ctrl:0
    v_add_f32_dpp v186, v149, v148 row_shl:2 row_mask:0xf bank_mask:0xf bound_ctrl:0
    v_add_f32_dpp v187, v151, v150 row_shl:2 row_mask:0xf bank_mask:0xf bound_ctrl:0
    v_add_f32_dpp v188, v153, v152 row_shl:2 row_mask:0xf bank_mask:0xf bound_ctrl:0
    v_add_f32_dpp v189, v155, v154 row_shl:2 row_mask:0xf bank_mask:0xf bound_ctrl:0
    s_nop 3
    v_add_f32_dpp v190, v157, v156 row_shl:2 row_mask:0xf bank_mask:0xf bound_ctrl:0
    v_add_f32_dpp v191, v159, v158 row_shl:2 row_mask:0xf bank_mask:0xf bound_ctrl:0
    v_add_f32_dpp v232, v185, v184 row_shl:4 row_mask:0xf bank_mask:0xf bound_ctrl:0
    v_add_f32_dpp v233, v187, v186 row_shl:4 row_mask:0xf bank_mask:0xf bound_ctrl:0
    v_add_f32_dpp v234, v189, v188 row_shl:4 row_mask:0xf bank_mask:0xf bound_ctrl:0
    v_add_f32_dpp v235, v191, v190 row_shl:4 row_mask:0xf bank_mask:0xf bound_ctrl:0
    s_waitcnt vmcnt(31)
    v_mfma_f32_16x16x32_bf16 v[144:147], v[48:51], v[208:211], 0
    s_add_u32 s10, s12, 0
    s_lshl_b32 s10, s10, 13
    s_add_u32 s11, s10, 4096
    buffer_load_dwordx4 v[48:51], v6, s[48:51], s10 offen offset:0 nt
    s_waitcnt vmcnt(31)
    v_mfma_f32_16x16x32_bf16 v[144:147], v[52:55], v[212:215], v[144:147]
    buffer_load_dwordx4 v[52:55], v6, s[48:51], s10 offen offset:2048 nt
    s_waitcnt vmcnt(31)
    v_mfma_f32_16x16x32_bf16 v[148:151], v[56:59], v[208:211], 0
    buffer_load_dwordx4 v[56:59], v6, s[48:51], s11 offen offset:0 nt
    s_waitcnt vmcnt(31)
    v_mfma_f32_16x16x32_bf16 v[148:151], v[60:63], v[212:215], v[148:151]
    buffer_load_dwordx4 v[60:63], v6, s[48:51], s11 offen offset:2048 nt
    s_waitcnt vmcnt(31)
    v_mfma_f32_16x16x32_bf16 v[152:155], v[64:67], v[208:211], 0
    buffer_load_dwordx4 v[64:67], v6, s[48:51], s10 offen offset:256 nt
    s_waitcnt vmcnt(31)
    v_mfma_f32_16x16x32_bf16 v[152:155], v[68:71], v[212:215], v[152:155]
    buffer_load_dwordx4 v[68:71], v6, s[48:51], s10 offen offset:2304 nt
    s_waitcnt vmcnt(31)
    v_mfma_f32_16x16x32_bf16 v[156:159], v[72:75], v[208:211], 0
    buffer_load_dwordx4 v[72:75], v6, s[48:51], s11 offen offset:256 nt
    s_waitcnt vmcnt(31)
    v_mfma_f32_16x16x32_bf16 v[156:159], v[76:79], v[212:215], v[156:159]
    buffer_load_dwordx4 v[76:79], v6, s[48:51], s11 offen offset:2304 nt
    v_add_f32_dpp v184, v145, v144 row_shl:2 row_mask:0xf bank_mask:0xf bound_ctrl:0
    v_add_f32_dpp v185, v147, v146 row_shl:2 row_mask:0xf bank_mask:0xf bound_ctrl:0
    v_add_f32_dpp v186, v149, v148 row_shl:2 row_mask:0xf bank_mask:0xf bound_ctrl:0
    v_add_f32_dpp v187, v151, v150 row_shl:2 row_mask:0xf bank_mask:0xf bound_ctrl:0
    v_add_f32_dpp v188, v153, v152 row_shl:2 row_mask:0xf bank_mask:0xf bound_ctrl:0
    v_add_f32_dpp v189, v155, v154 row_shl:2 row_mask:0xf bank_mask:0xf bound_ctrl:0
    s_nop 3
    v_add_f32_dpp v190, v157, v156 row_shl:2 row_mask:0xf bank_mask:0xf bound_ctrl:0
    v_add_f32_dpp v191, v159, v158 row_shl:2 row_mask:0xf bank_mask:0xf bound_ctrl:0
    v_add_f32_dpp v236, v185, v184 row_shl:4 row_mask:0xf bank_mask:0xf bound_ctrl:0
    v_add_f32_dpp v237, v187, v186 row_shl:4 row_mask:0xf bank_mask:0xf bound_ctrl:0
    v_add_f32_dpp v238, v189, v188 row_shl:4 row_mask:0xf bank_mask:0xf bound_ctrl:0
    v_add_f32_dpp v239, v191, v190 row_shl:4 row_mask:0xf bank_mask:0xf bound_ctrl:0
    s_waitcnt vmcnt(31)
    v_mfma_f32_16x16x32_bf16 v[144:147], v[80:83], v[208:211], 0
    s_add_u32 s10, s12, 8
    s_lshl_b32 s10, s10, 13
    s_add_u32 s11, s10, 4096
    buffer_load_dwordx4 v[80:83], v6, s[48:51], s10 offen offset:0 nt
    s_waitcnt vmcnt(31)
    v_mfma_f32_16x16x32_bf16 v[144:147], v[84:87], v[212:215], v[144:147]
    buffer_load_dwordx4 v[84:87], v6, s[48:51], s10 offen offset:2048 nt
    s_waitcnt vmcnt(31)
    v_mfma_f32_16x16x32_bf16 v[148:151], v[88:91], v[208:211], 0
    buffer_load_dwordx4 v[88:91], v6, s[48:51], s11 offen offset:0 nt
    s_waitcnt vmcnt(31)
    v_mfma_f32_16x16x32_bf16 v[148:151], v[92:95], v[212:215], v[148:151]
    buffer_load_dwordx4 v[92:95], v6, s[48:51], s11 offen offset:2048 nt
    s_waitcnt vmcnt(31)
    v_mfma_f32_16x16x32_bf16 v[152:155], v[96:99], v[208:211], 0
    buffer_load_dwordx4 v[96:99], v6, s[48:51], s10 offen offset:256 nt
    s_waitcnt vmcnt(31)
    v_mfma_f32_16x16x32_bf16 v[152:155], v[100:103], v[212:215], v[152:155]
    buffer_load_dwordx4 v[100:103], v6, s[48:51], s10 offen offset:2304 nt
    s_waitcnt vmcnt(31)
    v_mfma_f32_16x16x32_bf16 v[156:159], v[104:107], v[208:211], 0
    buffer_load_dwordx4 v[104:107], v6, s[48:51], s11 offen offset:256 nt
    s_waitcnt vmcnt(31)
    v_mfma_f32_16x16x32_bf16 v[156:159], v[108:111], v[212:215], v[156:159]
    buffer_load_dwordx4 v[108:111], v6, s[48:51], s11 offen offset:2304 nt
    v_add_f32_dpp v184, v145, v144 row_shl:2 row_mask:0xf bank_mask:0xf bound_ctrl:0
    v_add_f32_dpp v185, v147, v146 row_shl:2 row_mask:0xf bank_mask:0xf bound_ctrl:0
    v_add_f32_dpp v186, v149, v148 row_shl:2 row_mask:0xf bank_mask:0xf bound_ctrl:0
    v_add_f32_dpp v187, v151, v150 row_shl:2 row_mask:0xf bank_mask:0xf bound_ctrl:0
    v_add_f32_dpp v188, v153, v152 row_shl:2 row_mask:0xf bank_mask:0xf bound_ctrl:0
    v_add_f32_dpp v189, v155, v154 row_shl:2 row_mask:0xf bank_mask:0xf bound_ctrl:0
    s_nop 3
    v_add_f32_dpp v190, v157, v156 row_shl:2 row_mask:0xf bank_mask:0xf bound_ctrl:0
    v_add_f32_dpp v191, v159, v158 row_shl:2 row_mask:0xf bank_mask:0xf bound_ctrl:0
    v_add_f32_dpp v240, v185, v184 row_shl:4 row_mask:0xf bank_mask:0xf bound_ctrl:0
    v_add_f32_dpp v241, v187, v186 row_shl:4 row_mask:0xf bank_mask:0xf bound_ctrl:0
    v_add_f32_dpp v242, v189, v188 row_shl:4 row_mask:0xf bank_mask:0xf bound_ctrl:0
    v_add_f32_dpp v243, v191, v190 row_shl:4 row_mask:0xf bank_mask:0xf bound_ctrl:0
    s_waitcnt vmcnt(31)
    v_mfma_f32_16x16x32_bf16 v[144:147], v[112:115], v[208:211], 0
    s_add_u32 s10, s12, 16
    s_lshl_b32 s10, s10, 13
    s_add_u32 s11, s10, 4096
    buffer_load_dwordx4 v[112:115], v6, s[48:51], s10 offen offset:0 nt
    s_waitcnt vmcnt(31)
    v_mfma_f32_16x16x32_bf16 v[144:147], v[116:119], v[212:215], v[144:147]
    buffer_load_dwordx4 v[116:119], v6, s[48:51], s10 offen offset:2048 nt
    s_waitcnt vmcnt(31)
    v_mfma_f32_16x16x32_bf16 v[148:151], v[120:123], v[208:211], 0
    buffer_load_dwordx4 v[120:123], v6, s[48:51], s11 offen offset:0 nt
    s_waitcnt vmcnt(31)
    v_mfma_f32_16x16x32_bf16 v[148:151], v[124:127], v[212:215], v[148:151]
    buffer_load_dwordx4 v[124:127], v6, s[48:51], s11 offen offset:2048 nt
    s_waitcnt vmcnt(31)
    v_mfma_f32_16x16x32_bf16 v[152:155], v[128:131], v[208:211], 0
    buffer_load_dwordx4 v[128:131], v6, s[48:51], s10 offen offset:256 nt
    s_waitcnt vmcnt(31)
    v_mfma_f32_16x16x32_bf16 v[152:155], v[132:135], v[212:215], v[152:155]
    buffer_load_dwordx4 v[132:135], v6, s[48:51], s10 offen offset:2304 nt
    s_waitcnt vmcnt(31)
    v_mfma_f32_16x16x32_bf16 v[156:159], v[136:139], v[208:211], 0
    buffer_load_dwordx4 v[136:139], v6, s[48:51], s11 offen offset:256 nt
    s_waitcnt vmcnt(31)
    v_mfma_f32_16x16x32_bf16 v[156:159], v[140:143], v[212:215], v[156:159]
    buffer_load_dwordx4 v[140:143], v6, s[48:51], s11 offen offset:2304 nt
    v_add_f32_dpp v184, v145, v144 row_shl:2 row_mask:0xf bank_mask:0xf bound_ctrl:0
    v_add_f32_dpp v185, v147, v146 row_shl:2 row_mask:0xf bank_mask:0xf bound_ctrl:0
    v_add_f32_dpp v186, v149, v148 row_shl:2 row_mask:0xf bank_mask:0xf bound_ctrl:0
    v_add_f32_dpp v187, v151, v150 row_shl:2 row_mask:0xf bank_mask:0xf bound_ctrl:0
    v_add_f32_dpp v188, v153, v152 row_shl:2 row_mask:0xf bank_mask:0xf bound_ctrl:0
    v_add_f32_dpp v189, v155, v154 row_shl:2 row_mask:0xf bank_mask:0xf bound_ctrl:0
    s_nop 3
    v_add_f32_dpp v190, v157, v156 row_shl:2 row_mask:0xf bank_mask:0xf bound_ctrl:0
    v_add_f32_dpp v191, v159, v158 row_shl:2 row_mask:0xf bank_mask:0xf bound_ctrl:0
    v_add_f32_dpp v244, v185, v184 row_shl:4 row_mask:0xf bank_mask:0xf bound_ctrl:0
    v_add_f32_dpp v245, v187, v186 row_shl:4 row_mask:0xf bank_mask:0xf bound_ctrl:0
    v_add_f32_dpp v246, v189, v188 row_shl:4 row_mask:0xf bank_mask:0xf bound_ctrl:0
    v_add_f32_dpp v247, v191, v190 row_shl:4 row_mask:0xf bank_mask:0xf bound_ctrl:0
    v_add_f32 v244, s40, v244
    v_add_f32 v245, s40, v245
    v_add_f32 v246, s40, v246
    v_add_f32 v247, s40, v247
    s_waitcnt vmcnt(31)
    v_mfma_f32_16x16x32_bf16 v[144:147], v[16:19], v[208:211], 0
    s_add_u32 s10, s12, 24
    s_lshl_b32 s10, s10, 13
    s_add_u32 s11, s10, 4096
    buffer_load_dwordx4 v[16:19], v6, s[48:51], s10 offen offset:0 nt
    s_waitcnt vmcnt(31)
    v_mfma_f32_16x16x32_bf16 v[144:147], v[20:23], v[212:215], v[144:147]
    buffer_load_dwordx4 v[20:23], v6, s[48:51], s10 offen offset:2048 nt
    s_waitcnt vmcnt(31)
    v_mfma_f32_16x16x32_bf16 v[148:151], v[24:27], v[208:211], 0
    buffer_load_dwordx4 v[24:27], v6, s[48:51], s11 offen offset:0 nt
    s_waitcnt vmcnt(31)
    v_mfma_f32_16x16x32_bf16 v[148:151], v[28:31], v[212:215], v[148:151]
    buffer_load_dwordx4 v[28:31], v6, s[48:51], s11 offen offset:2048 nt
    s_waitcnt vmcnt(31)
    v_mfma_f32_16x16x32_bf16 v[152:155], v[32:35], v[208:211], 0
    buffer_load_dwordx4 v[32:35], v6, s[48:51], s10 offen offset:256 nt
    s_waitcnt vmcnt(31)
    v_mfma_f32_16x16x32_bf16 v[152:155], v[36:39], v[212:215], v[152:155]
    buffer_load_dwordx4 v[36:39], v6, s[48:51], s10 offen offset:2304 nt
    s_waitcnt vmcnt(31)
    v_mfma_f32_16x16x32_bf16 v[156:159], v[40:43], v[208:211], 0
    buffer_load_dwordx4 v[40:43], v6, s[48:51], s11 offen offset:256 nt
    s_waitcnt vmcnt(31)
    v_mfma_f32_16x16x32_bf16 v[156:159], v[44:47], v[212:215], v[156:159]
    buffer_load_dwordx4 v[44:47], v6, s[48:51], s11 offen offset:2304 nt
    v_add_f32_dpp v184, v145, v144 row_shl:2 row_mask:0xf bank_mask:0xf bound_ctrl:0
    v_add_f32_dpp v185, v147, v146 row_shl:2 row_mask:0xf bank_mask:0xf bound_ctrl:0
    v_add_f32_dpp v186, v149, v148 row_shl:2 row_mask:0xf bank_mask:0xf bound_ctrl:0
    v_add_f32_dpp v187, v151, v150 row_shl:2 row_mask:0xf bank_mask:0xf bound_ctrl:0
    v_add_f32_dpp v188, v153, v152 row_shl:2 row_mask:0xf bank_mask:0xf bound_ctrl:0
    v_add_f32_dpp v189, v155, v154 row_shl:2 row_mask:0xf bank_mask:0xf bound_ctrl:0
    s_nop 3
    v_add_f32_dpp v190, v157, v156 row_shl:2 row_mask:0xf bank_mask:0xf bound_ctrl:0
    v_add_f32_dpp v191, v159, v158 row_shl:2 row_mask:0xf bank_mask:0xf bound_ctrl:0
    v_add_f32_dpp v248, v185, v184 row_shl:4 row_mask:0xf bank_mask:0xf bound_ctrl:0
    v_add_f32_dpp v249, v187, v186 row_shl:4 row_mask:0xf bank_mask:0xf bound_ctrl:0
    v_add_f32_dpp v250, v189, v188 row_shl:4 row_mask:0xf bank_mask:0xf bound_ctrl:0
    v_add_f32_dpp v251, v191, v190 row_shl:4 row_mask:0xf bank_mask:0xf bound_ctrl:0
    v_add_f32 v248, s41, v248
    v_add_f32 v249, s41, v249
    v_add_f32 v250, s41, v250
    v_add_f32 v251, s41, v251
    v_mov_b32 v176, 0
    v_mov_b32 v177, 0
    v_mov_b32 v178, 0
    v_mov_b32 v179, 0
    v_mov_b32 v180, 0
    v_mov_b32 v181, 0
    v_mov_b32 v182, 0
    v_mov_b32 v183, 0
    v_mov_b32 v184, 0
    v_mov_b32 v185, 0
    v_mov_b32 v186, 0
    v_mov_b32 v187, 0
    v_mov_b32 v188, 0
    v_mov_b32 v189, 0
    v_mov_b32 v190, 0
    v_mov_b32 v191, 0
    v_mov_b32 v192, 0
    v_mov_b32 v193, 0
    v_mov_b32 v194, 0
    v_mov_b32 v195, 0
    v_mov_b32 v196, 0
    v_mov_b32 v197, 0
    v_mov_b32 v198, 0
    v_mov_b32 v199, 0
    v_mov_b32 v200, 0
    v_mov_b32 v201, 0
    v_mov_b32 v202, 0
    v_mov_b32 v203, 0
    v_mov_b32 v204, 0
    v_mov_b32 v205, 0
    v_mov_b32 v206, 0
    v_mov_b32 v207, 0
    v_max_f32 v11, v216, v217
    v_max_f32 v12, v218, v219
    v_max3_f32 v11, v11, v220, v221
    v_max3_f32 v12, v12, v222, v223
    v_max3_f32 v11, v11, v224, v225
    v_max3_f32 v12, v12, v226, v227
    v_max3_f32 v11, v11, v228, v229
    v_max3_f32 v12, v12, v230, v231
    v_max3_f32 v11, v11, v232, v233
    v_max3_f32 v12, v12, v234, v235
    v_max3_f32 v11, v11, v236, v237
    v_max3_f32 v12, v12, v238, v239
    v_max3_f32 v11, v11, v240, v241
    v_max3_f32 v12, v12, v242, v243
    v_max3_f32 v11, v11, v244, v245
    v_max3_f32 v12, v12, v246, v247
    v_max3_f32 v11, v11, v248, v249
    v_max3_f32 v12, v12, v250, v251
    v_max_f32 v11, v11, v12
    v_mov_b32 v12, v11
    s_nop 1
    v_permlane32_swap_b32 v11, v12
    s_nop 1
    v_max_f32 v11, v11, v12
    v_mov_b32 v12, v11
    s_nop 1
    v_permlane16_swap_b32 v11, v12
    s_nop 1
    v_max_f32 v8, v11, v12
    v_mul_f32 v12, s82, v8
    v_fma_f32 v216, v216, s82, -v12
    v_fma_f32 v217, v217, s82, -v12
    v_fma_f32 v218, v218, s82, -v12
    v_fma_f32 v219, v219, s82, -v12
    v_fma_f32 v220, v220, s82, -v12
    v_fma_f32 v221, v221, s82, -v12
    v_fma_f32 v222, v222, s82, -v12
    v_fma_f32 v223, v223, s82, -v12
    v_fma_f32 v224, v224, s82, -v12
    v_fma_f32 v225, v225, s82, -v12
    v_fma_f32 v226, v226, s82, -v12
    v_fma_f32 v227, v227, s82, -v12
    v_fma_f32 v228, v228, s82, -v12
    v_fma_f32 v229, v229, s82, -v12
    v_fma_f32 v230, v230, s82, -v12
    v_fma_f32 v231, v231, s82, -v12
    v_fma_f32 v232, v232, s82, -v12
    v_fma_f32 v233, v233, s82, -v12
    v_fma_f32 v234, v234, s82, -v12
    v_fma_f32 v235, v235, s82, -v12
    v_fma_f32 v236, v236, s82, -v12
    v_fma_f32 v237, v237, s82, -v12
    v_fma_f32 v238, v238, s82, -v12
    v_fma_f32 v239, v239, s82, -v12
    v_fma_f32 v240, v240, s82, -v12
    v_fma_f32 v241, v241, s82, -v12
    v_fma_f32 v242, v242, s82, -v12
    v_fma_f32 v243, v243, s82, -v12
    v_fma_f32 v244, v244, s82, -v12
    v_fma_f32 v245, v245, s82, -v12
    v_fma_f32 v246, v246, s82, -v12
    v_fma_f32 v247, v247, s82, -v12
    v_fma_f32 v248, v248, s82, -v12
    v_fma_f32 v249, v249, s82, -v12
    v_fma_f32 v250, v250, s82, -v12
    v_fma_f32 v251, v251, s82, -v12
    v_exp_f32 v216, v216
    v_exp_f32 v217, v217
    v_exp_f32 v218, v218
    v_exp_f32 v219, v219
    v_exp_f32 v220, v220
    v_exp_f32 v221, v221
    v_exp_f32 v222, v222
    v_exp_f32 v223, v223
    v_exp_f32 v224, v224
    v_exp_f32 v225, v225
    v_exp_f32 v226, v226
    v_exp_f32 v227, v227
    v_exp_f32 v228, v228
    v_exp_f32 v229, v229
    v_exp_f32 v230, v230
    v_exp_f32 v231, v231
    v_exp_f32 v232, v232
    v_exp_f32 v233, v233
    v_exp_f32 v234, v234
    v_exp_f32 v235, v235
    v_exp_f32 v236, v236
    v_exp_f32 v237, v237
    v_exp_f32 v238, v238
    v_exp_f32 v239, v239
    v_exp_f32 v240, v240
    v_exp_f32 v241, v241
    v_exp_f32 v242, v242
    v_exp_f32 v243, v243
    v_exp_f32 v244, v244
    v_exp_f32 v245, v245
    v_exp_f32 v246, v246
    v_exp_f32 v247, v247
    v_exp_f32 v248, v248
    v_exp_f32 v249, v249
    v_exp_f32 v250, v250
    v_exp_f32 v251, v251
    s_nop 0
    v_add_f32 v9, v216, v217
    v_add_f32 v13, v218, v219
    v_add_f32 v11, v220, v221
    v_add_f32 v9, v9, v11
    v_add_f32 v11, v222, v223
    v_add_f32 v13, v13, v11
    v_add_f32 v11, v224, v225
    v_add_f32 v9, v9, v11
    v_add_f32 v11, v226, v227
    v_add_f32 v13, v13, v11
    v_add_f32 v11, v228, v229
    v_add_f32 v9, v9, v11
    v_add_f32 v11, v230, v231
    v_add_f32 v13, v13, v11
    v_add_f32 v11, v232, v233
    v_add_f32 v9, v9, v11
    v_add_f32 v11, v234, v235
    v_add_f32 v13, v13, v11
    v_add_f32 v11, v236, v237
    v_add_f32 v9, v9, v11
    v_add_f32 v11, v238, v239
    v_add_f32 v13, v13, v11
    v_add_f32 v11, v240, v241
    v_add_f32 v9, v9, v11
    v_add_f32 v11, v242, v243
    v_add_f32 v13, v13, v11
    v_add_f32 v11, v244, v245
    v_add_f32 v9, v9, v11
    v_add_f32 v11, v246, v247
    v_add_f32 v13, v13, v11
    v_add_f32 v11, v248, v249
    v_add_f32 v9, v9, v11
    v_add_f32 v11, v250, v251
    v_add_f32 v13, v13, v11
    v_add_f32 v9, v9, v13
    v_cvt_pk_bf16_f32 v216, v216, v217
    v_cvt_pk_bf16_f32 v217, v218, v219
    v_cvt_pk_bf16_f32 v220, v220, v221
    v_cvt_pk_bf16_f32 v221, v222, v223
    v_cvt_pk_bf16_f32 v224, v224, v225
    v_cvt_pk_bf16_f32 v225, v226, v227
    v_cvt_pk_bf16_f32 v228, v228, v229
    v_cvt_pk_bf16_f32 v229, v230, v231
    v_cvt_pk_bf16_f32 v232, v232, v233
    v_cvt_pk_bf16_f32 v233, v234, v235
    v_cvt_pk_bf16_f32 v236, v236, v237
    v_cvt_pk_bf16_f32 v237, v238, v239
    v_cvt_pk_bf16_f32 v240, v240, v241
    v_cvt_pk_bf16_f32 v241, v242, v243
    v_cvt_pk_bf16_f32 v244, v244, v245
    v_cvt_pk_bf16_f32 v245, v246, v247
    v_cvt_pk_bf16_f32 v248, v248, v249
    v_cvt_pk_bf16_f32 v249, v250, v251
    v_and_b32 v216, v216, v10
    v_and_b32 v217, v217, v10
    v_and_b32 v220, v220, v10
    v_and_b32 v221, v221, v10
    v_and_b32 v224, v224, v10
    v_and_b32 v225, v225, v10
    v_and_b32 v228, v228, v10
    v_and_b32 v229, v229, v10
    v_and_b32 v232, v232, v10
    v_and_b32 v233, v233, v10
    v_and_b32 v236, v236, v10
    v_and_b32 v237, v237, v10
    v_and_b32 v240, v240, v10
    v_and_b32 v241, v241, v10
    v_and_b32 v244, v244, v10
    v_and_b32 v245, v245, v10
    v_and_b32 v248, v248, v10
    v_and_b32 v249, v249, v10
    v_mov_b32_dpp v218, v216 row_shr:2 row_mask:0xf bank_mask:0xf bound_ctrl:0
    v_mov_b32_dpp v219, v217 row_shr:2 row_mask:0xf bank_mask:0xf bound_ctrl:0
    v_mov_b32_dpp v222, v220 row_shr:2 row_mask:0xf bank_mask:0xf bound_ctrl:0
    v_mov_b32_dpp v223, v221 row_shr:2 row_mask:0xf bank_mask:0xf bound_ctrl:0
    v_mov_b32_dpp v226, v224 row_shr:2 row_mask:0xf bank_mask:0xf bound_ctrl:0
    v_mov_b32_dpp v227, v225 row_shr:2 row_mask:0xf bank_mask:0xf bound_ctrl:0
    v_mov_b32_dpp v230, v228 row_shr:2 row_mask:0xf bank_mask:0xf bound_ctrl:0
    v_mov_b32_dpp v231, v229 row_shr:2 row_mask:0xf bank_mask:0xf bound_ctrl:0
    v_mov_b32_dpp v234, v232 row_shr:2 row_mask:0xf bank_mask:0xf bound_ctrl:0
    v_mov_b32_dpp v235, v233 row_shr:2 row_mask:0xf bank_mask:0xf bound_ctrl:0
    v_mov_b32_dpp v238, v236 row_shr:2 row_mask:0xf bank_mask:0xf bound_ctrl:0
    v_mov_b32_dpp v239, v237 row_shr:2 row_mask:0xf bank_mask:0xf bound_ctrl:0
    v_mov_b32_dpp v242, v240 row_shr:2 row_mask:0xf bank_mask:0xf bound_ctrl:0
    v_mov_b32_dpp v243, v241 row_shr:2 row_mask:0xf bank_mask:0xf bound_ctrl:0
    v_mov_b32_dpp v246, v244 row_shr:2 row_mask:0xf bank_mask:0xf bound_ctrl:0
    v_mov_b32_dpp v247, v245 row_shr:2 row_mask:0xf bank_mask:0xf bound_ctrl:0
    v_mov_b32_dpp v250, v248 row_shr:2 row_mask:0xf bank_mask:0xf bound_ctrl:0
    v_mov_b32_dpp v251, v249 row_shr:2 row_mask:0xf bank_mask:0xf bound_ctrl:0
    s_waitcnt vmcnt(30)
    v_perm_b32 v144, v52, v48, s80
    v_perm_b32 v148, v52, v48, s81
    v_perm_b32 v152, v53, v49, s80
    v_perm_b32 v156, v53, v49, s81
    v_perm_b32 v160, v54, v50, s80
    v_perm_b32 v164, v54, v50, s81
    v_perm_b32 v168, v55, v51, s80
    v_perm_b32 v172, v55, v51, s81
    s_add_u32 s10, s100, 32
    s_lshl_b32 s10, s10, 13
    s_add_u32 s11, s10, 4096
    buffer_load_dwordx4 v[48:51], v6, s[48:51], s10 offen offset:0 nt
    buffer_load_dwordx4 v[52:55], v6, s[48:51], s10 offen offset:2048 nt
    s_waitcnt vmcnt(30)
    v_perm_b32 v145, v60, v56, s80
    v_perm_b32 v149, v60, v56, s81
    v_perm_b32 v153, v61, v57, s80
    v_perm_b32 v157, v61, v57, s81
    v_perm_b32 v161, v62, v58, s80
    v_perm_b32 v165, v62, v58, s81
    v_perm_b32 v169, v63, v59, s80
    v_perm_b32 v173, v63, v59, s81
    buffer_load_dwordx4 v[56:59], v6, s[48:51], s11 offen offset:0 nt
    buffer_load_dwordx4 v[60:63], v6, s[48:51], s11 offen offset:2048 nt
    s_waitcnt vmcnt(30)
    v_perm_b32 v146, v68, v64, s80
    v_perm_b32 v150, v68, v64, s81
    v_perm_b32 v154, v69, v65, s80
    v_perm_b32 v158, v69, v65, s81
    v_perm_b32 v162, v70, v66, s80
    v_perm_b32 v166, v70, v66, s81
    v_perm_b32 v170, v71, v67, s80
    v_perm_b32 v174, v71, v67, s81
    buffer_load_dwordx4 v[64:67], v6, s[48:51], s10 offen offset:256 nt
    buffer_load_dwordx4 v[68:71], v6, s[48:51], s10 offen offset:2304 nt
    s_waitcnt vmcnt(30)
    v_perm_b32 v147, v76, v72, s80
    v_perm_b32 v151, v76, v72, s81
    v_perm_b32 v155, v77, v73, s80
    v_perm_b32 v159, v77, v73, s81
    v_perm_b32 v163, v78, v74, s80
    v_perm_b32 v167, v78, v74, s81
    v_perm_b32 v171, v79, v75, s80
    v_perm_b32 v175, v79, v75, s81
    buffer_load_dwordx4 v[72:75], v6, s[48:51], s11 offen offset:256 nt
    buffer_load_dwordx4 v[76:79], v6, s[48:51], s11 offen offset:2304 nt
    s_nop 1
    v_mfma_f32_16x16x32_bf16 v[176:179], v[216:219], v[144:147], v[176:179]
    v_mfma_f32_16x16x32_bf16 v[180:183], v[216:219], v[148:151], v[180:183]
    v_mfma_f32_16x16x32_bf16 v[184:187], v[216:219], v[152:155], v[184:187]
    v_mfma_f32_16x16x32_bf16 v[188:191], v[216:219], v[156:159], v[188:191]
    v_mfma_f32_16x16x32_bf16 v[192:195], v[216:219], v[160:163], v[192:195]
    v_mfma_f32_16x16x32_bf16 v[196:199], v[216:219], v[164:167], v[196:199]
    v_mfma_f32_16x16x32_bf16 v[200:203], v[216:219], v[168:171], v[200:203]
    v_mfma_f32_16x16x32_bf16 v[204:207], v[216:219], v[172:175], v[204:207]
    s_waitcnt vmcnt(30)
    v_perm_b32 v144, v84, v80, s80
    v_perm_b32 v148, v84, v80, s81
    v_perm_b32 v152, v85, v81, s80
    v_perm_b32 v156, v85, v81, s81
    v_perm_b32 v160, v86, v82, s80
    v_perm_b32 v164, v86, v82, s81
    v_perm_b32 v168, v87, v83, s80
    v_perm_b32 v172, v87, v83, s81
    s_add_u32 s10, s100, 40
    s_lshl_b32 s10, s10, 13
    s_add_u32 s11, s10, 4096
    buffer_load_dwordx4 v[80:83], v6, s[48:51], s10 offen offset:0 nt
    buffer_load_dwordx4 v[84:87], v6, s[48:51], s10 offen offset:2048 nt
    s_waitcnt vmcnt(30)
    v_perm_b32 v145, v92, v88, s80
    v_perm_b32 v149, v92, v88, s81
    v_perm_b32 v153, v93, v89, s80
    v_perm_b32 v157, v93, v89, s81
    v_perm_b32 v161, v94, v90, s80
    v_perm_b32 v165, v94, v90, s81
    v_perm_b32 v169, v95, v91, s80
    v_perm_b32 v173, v95, v91, s81
    buffer_load_dwordx4 v[88:91], v6, s[48:51], s11 offen offset:0 nt
    buffer_load_dwordx4 v[92:95], v6, s[48:51], s11 offen offset:2048 nt
    s_waitcnt vmcnt(30)
    v_perm_b32 v146, v100, v96, s80
    v_perm_b32 v150, v100, v96, s81
    v_perm_b32 v154, v101, v97, s80
    v_perm_b32 v158, v101, v97, s81
    v_perm_b32 v162, v102, v98, s80
    v_perm_b32 v166, v102, v98, s81
    v_perm_b32 v170, v103, v99, s80
    v_perm_b32 v174, v103, v99, s81
    buffer_load_dwordx4 v[96:99], v6, s[48:51], s10 offen offset:256 nt
    buffer_load_dwordx4 v[100:103], v6, s[48:51], s10 offen offset:2304 nt
    s_waitcnt vmcnt(30)
    v_perm_b32 v147, v108, v104, s80
    v_perm_b32 v151, v108, v104, s81
    v_perm_b32 v155, v109, v105, s80
    v_perm_b32 v159, v109, v105, s81
    v_perm_b32 v163, v110, v106, s80
    v_perm_b32 v167, v110, v106, s81
    v_perm_b32 v171, v111, v107, s80
    v_perm_b32 v175, v111, v107, s81
    buffer_load_dwordx4 v[104:107], v6, s[48:51], s11 offen offset:256 nt
    buffer_load_dwordx4 v[108:111], v6, s[48:51], s11 offen offset:2304 nt
    s_nop 1
    v_mfma_f32_16x16x32_bf16 v[176:179], v[220:223], v[144:147], v[176:179]
    v_mfma_f32_16x16x32_bf16 v[180:183], v[220:223], v[148:151], v[180:183]
    v_mfma_f32_16x16x32_bf16 v[184:187], v[220:223], v[152:155], v[184:187]
    v_mfma_f32_16x16x32_bf16 v[188:191], v[220:223], v[156:159], v[188:191]
    v_mfma_f32_16x16x32_bf16 v[192:195], v[220:223], v[160:163], v[192:195]
    v_mfma_f32_16x16x32_bf16 v[196:199], v[220:223], v[164:167], v[196:199]
    v_mfma_f32_16x16x32_bf16 v[200:203], v[220:223], v[168:171], v[200:203]
    v_mfma_f32_16x16x32_bf16 v[204:207], v[220:223], v[172:175], v[204:207]
    s_waitcnt vmcnt(30)
    v_perm_b32 v144, v116, v112, s80
    v_perm_b32 v148, v116, v112, s81
    v_perm_b32 v152, v117, v113, s80
    v_perm_b32 v156, v117, v113, s81
    v_perm_b32 v160, v118, v114, s80
    v_perm_b32 v164, v118, v114, s81
    v_perm_b32 v168, v119, v115, s80
    v_perm_b32 v172, v119, v115, s81
    s_add_u32 s10, s100, 48
    s_lshl_b32 s10, s10, 13
    s_add_u32 s11, s10, 4096
    buffer_load_dwordx4 v[112:115], v6, s[48:51], s10 offen offset:0 nt
    buffer_load_dwordx4 v[116:119], v6, s[48:51], s10 offen offset:2048 nt
    s_waitcnt vmcnt(30)
    v_perm_b32 v145, v124, v120, s80
    v_perm_b32 v149, v124, v120, s81
    v_perm_b32 v153, v125, v121, s80
    v_perm_b32 v157, v125, v121, s81
    v_perm_b32 v161, v126, v122, s80
    v_perm_b32 v165, v126, v122, s81
    v_perm_b32 v169, v127, v123, s80
    v_perm_b32 v173, v127, v123, s81
    buffer_load_dwordx4 v[120:123], v6, s[48:51], s11 offen offset:0 nt
    buffer_load_dwordx4 v[124:127], v6, s[48:51], s11 offen offset:2048 nt
    s_waitcnt vmcnt(30)
    v_perm_b32 v146, v132, v128, s80
    v_perm_b32 v150, v132, v128, s81
    v_perm_b32 v154, v133, v129, s80
    v_perm_b32 v158, v133, v129, s81
    v_perm_b32 v162, v134, v130, s80
    v_perm_b32 v166, v134, v130, s81
    v_perm_b32 v170, v135, v131, s80
    v_perm_b32 v174, v135, v131, s81
    buffer_load_dwordx4 v[128:131], v6, s[48:51], s10 offen offset:256 nt
    buffer_load_dwordx4 v[132:135], v6, s[48:51], s10 offen offset:2304 nt
    s_waitcnt vmcnt(30)
    v_perm_b32 v147, v140, v136, s80
    v_perm_b32 v151, v140, v136, s81
    v_perm_b32 v155, v141, v137, s80
    v_perm_b32 v159, v141, v137, s81
    v_perm_b32 v163, v142, v138, s80
    v_perm_b32 v167, v142, v138, s81
    v_perm_b32 v171, v143, v139, s80
    v_perm_b32 v175, v143, v139, s81
    buffer_load_dwordx4 v[136:139], v6, s[48:51], s11 offen offset:256 nt
    buffer_load_dwordx4 v[140:143], v6, s[48:51], s11 offen offset:2304 nt
    s_nop 1
    v_mfma_f32_16x16x32_bf16 v[176:179], v[224:227], v[144:147], v[176:179]
    v_mfma_f32_16x16x32_bf16 v[180:183], v[224:227], v[148:151], v[180:183]
    v_mfma_f32_16x16x32_bf16 v[184:187], v[224:227], v[152:155], v[184:187]
    v_mfma_f32_16x16x32_bf16 v[188:191], v[224:227], v[156:159], v[188:191]
    v_mfma_f32_16x16x32_bf16 v[192:195], v[224:227], v[160:163], v[192:195]
    v_mfma_f32_16x16x32_bf16 v[196:199], v[224:227], v[164:167], v[196:199]
    v_mfma_f32_16x16x32_bf16 v[200:203], v[224:227], v[168:171], v[200:203]
    v_mfma_f32_16x16x32_bf16 v[204:207], v[224:227], v[172:175], v[204:207]
    s_waitcnt vmcnt(30)
    v_perm_b32 v144, v20, v16, s80
    v_perm_b32 v148, v20, v16, s81
    v_perm_b32 v152, v21, v17, s80
    v_perm_b32 v156, v21, v17, s81
    v_perm_b32 v160, v22, v18, s80
    v_perm_b32 v164, v22, v18, s81
    v_perm_b32 v168, v23, v19, s80
    v_perm_b32 v172, v23, v19, s81
    s_add_u32 s10, s100, 56
    s_lshl_b32 s10, s10, 13
    s_add_u32 s11, s9, 56
    s_cmp_lt_u32 s11, s13
    s_cselect_b32 s10, s10, 0x400000
    s_add_u32 s11, s10, 4096
    buffer_load_dwordx4 v[16:19], v6, s[48:51], s10 offen offset:0 nt
    buffer_load_dwordx4 v[20:23], v6, s[48:51], s10 offen offset:2048 nt
    s_waitcnt vmcnt(30)
    v_perm_b32 v145, v28, v24, s80
    v_perm_b32 v149, v28, v24, s81
    v_perm_b32 v153, v29, v25, s80
    v_perm_b32 v157, v29, v25, s81
    v_perm_b32 v161, v30, v26, s80
    v_perm_b32 v165, v30, v26, s81
    v_perm_b32 v169, v31, v27, s80
    v_perm_b32 v173, v31, v27, s81
    buffer_load_dwordx4 v[24:27], v6, s[48:51], s11 offen offset:0 nt
    buffer_load_dwordx4 v[28:31], v6, s[48:51], s11 offen offset:2048 nt
    s_waitcnt vmcnt(30)
    v_perm_b32 v146, v36, v32, s80
    v_perm_b32 v150, v36, v32, s81
    v_perm_b32 v154, v37, v33, s80
    v_perm_b32 v158, v37, v33, s81
    v_perm_b32 v162, v38, v34, s80
    v_perm_b32 v166, v38, v34, s81
    v_perm_b32 v170, v39, v35, s80
    v_perm_b32 v174, v39, v35, s81
    buffer_load_dwordx4 v[32:35], v6, s[48:51], s10 offen offset:256 nt
    buffer_load_dwordx4 v[36:39], v6, s[48:51], s10 offen offset:2304 nt
    s_waitcnt vmcnt(30)
    v_perm_b32 v147, v44, v40, s80
    v_perm_b32 v151, v44, v40, s81
    v_perm_b32 v155, v45, v41, s80
    v_perm_b32 v159, v45, v41, s81
    v_perm_b32 v163, v46, v42, s80
    v_perm_b32 v167, v46, v42, s81
    v_perm_b32 v171, v47, v43, s80
    v_perm_b32 v175, v47, v43, s81
    buffer_load_dwordx4 v[40:43], v6, s[48:51], s11 offen offset:256 nt
    buffer_load_dwordx4 v[44:47], v6, s[48:51], s11 offen offset:2304 nt
    s_nop 1
    v_mfma_f32_16x16x32_bf16 v[176:179], v[228:231], v[144:147], v[176:179]
    v_mfma_f32_16x16x32_bf16 v[180:183], v[228:231], v[148:151], v[180:183]
    v_mfma_f32_16x16x32_bf16 v[184:187], v[228:231], v[152:155], v[184:187]
    v_mfma_f32_16x16x32_bf16 v[188:191], v[228:231], v[156:159], v[188:191]
    v_mfma_f32_16x16x32_bf16 v[192:195], v[228:231], v[160:163], v[192:195]
    v_mfma_f32_16x16x32_bf16 v[196:199], v[228:231], v[164:167], v[196:199]
    v_mfma_f32_16x16x32_bf16 v[200:203], v[228:231], v[168:171], v[200:203]
    v_mfma_f32_16x16x32_bf16 v[204:207], v[228:231], v[172:175], v[204:207]
    s_waitcnt vmcnt(30)
    v_perm_b32 v144, v52, v48, s80
    v_perm_b32 v148, v52, v48, s81
    v_perm_b32 v152, v53, v49, s80
    v_perm_b32 v156, v53, v49, s81
    v_perm_b32 v160, v54, v50, s80
    v_perm_b32 v164, v54, v50, s81
    v_perm_b32 v168, v55, v51, s80
    v_perm_b32 v172, v55, v51, s81
    s_add_u32 s10, s100, 64
    s_lshl_b32 s10, s10, 13
    s_add_u32 s11, s9, 64
    s_cmp_lt_u32 s11, s13
    s_cselect_b32 s10, s10, 0x400000
    s_add_u32 s11, s10, 4096
    buffer_load_dwordx4 v[48:51], v6, s[48:51], s10 offen offset:0 nt
    buffer_load_dwordx4 v[52:55], v6, s[48:51], s10 offen offset:2048 nt
    s_waitcnt vmcnt(30)
    v_perm_b32 v145, v60, v56, s80
    v_perm_b32 v149, v60, v56, s81
    v_perm_b32 v153, v61, v57, s80
    v_perm_b32 v157, v61, v57, s81
    v_perm_b32 v161, v62, v58, s80
    v_perm_b32 v165, v62, v58, s81
    v_perm_b32 v169, v63, v59, s80
    v_perm_b32 v173, v63, v59, s81
    buffer_load_dwordx4 v[56:59], v6, s[48:51], s11 offen offset:0 nt
    buffer_load_dwordx4 v[60:63], v6, s[48:51], s11 offen offset:2048 nt
    s_waitcnt vmcnt(30)
    v_perm_b32 v146, v68, v64, s80
    v_perm_b32 v150, v68, v64, s81
    v_perm_b32 v154, v69, v65, s80
    v_perm_b32 v158, v69, v65, s81
    v_perm_b32 v162, v70, v66, s80
    v_perm_b32 v166, v70, v66, s81
    v_perm_b32 v170, v71, v67, s80
    v_perm_b32 v174, v71, v67, s81
    buffer_load_dwordx4 v[64:67], v6, s[48:51], s10 offen offset:256 nt
    buffer_load_dwordx4 v[68:71], v6, s[48:51], s10 offen offset:2304 nt
    s_waitcnt vmcnt(30)
    v_perm_b32 v147, v76, v72, s80
    v_perm_b32 v151, v76, v72, s81
    v_perm_b32 v155, v77, v73, s80
    v_perm_b32 v159, v77, v73, s81
    v_perm_b32 v163, v78, v74, s80
    v_perm_b32 v167, v78, v74, s81
    v_perm_b32 v171, v79, v75, s80
    v_perm_b32 v175, v79, v75, s81
    buffer_load_dwordx4 v[72:75], v6, s[48:51], s11 offen offset:256 nt
    buffer_load_dwordx4 v[76:79], v6, s[48:51], s11 offen offset:2304 nt
    s_nop 1
    v_mfma_f32_16x16x32_bf16 v[176:179], v[232:235], v[144:147], v[176:179]
    v_mfma_f32_16x16x32_bf16 v[180:183], v[232:235], v[148:151], v[180:183]
    v_mfma_f32_16x16x32_bf16 v[184:187], v[232:235], v[152:155], v[184:187]
    v_mfma_f32_16x16x32_bf16 v[188:191], v[232:235], v[156:159], v[188:191]
    v_mfma_f32_16x16x32_bf16 v[192:195], v[232:235], v[160:163], v[192:195]
    v_mfma_f32_16x16x32_bf16 v[196:199], v[232:235], v[164:167], v[196:199]
    v_mfma_f32_16x16x32_bf16 v[200:203], v[232:235], v[168:171], v[200:203]
    v_mfma_f32_16x16x32_bf16 v[204:207], v[232:235], v[172:175], v[204:207]
    s_waitcnt vmcnt(30)
    v_perm_b32 v144, v84, v80, s80
    v_perm_b32 v148, v84, v80, s81
    v_perm_b32 v152, v85, v81, s80
    v_perm_b32 v156, v85, v81, s81
    v_perm_b32 v160, v86, v82, s80
    v_perm_b32 v164, v86, v82, s81
    v_perm_b32 v168, v87, v83, s80
    v_perm_b32 v172, v87, v83, s81
    s_waitcnt vmcnt(28)
    v_perm_b32 v145, v92, v88, s80
    v_perm_b32 v149, v92, v88, s81
    v_perm_b32 v153, v93, v89, s80
    v_perm_b32 v157, v93, v89, s81
    v_perm_b32 v161, v94, v90, s80
    v_perm_b32 v165, v94, v90, s81
    v_perm_b32 v169, v95, v91, s80
    v_perm_b32 v173, v95, v91, s81
    s_waitcnt vmcnt(26)
    v_perm_b32 v146, v100, v96, s80
    v_perm_b32 v150, v100, v96, s81
    v_perm_b32 v154, v101, v97, s80
    v_perm_b32 v158, v101, v97, s81
    v_perm_b32 v162, v102, v98, s80
    v_perm_b32 v166, v102, v98, s81
    v_perm_b32 v170, v103, v99, s80
    v_perm_b32 v174, v103, v99, s81
    s_waitcnt vmcnt(24)
    v_perm_b32 v147, v108, v104, s80
    v_perm_b32 v151, v108, v104, s81
    v_perm_b32 v155, v109, v105, s80
    v_perm_b32 v159, v109, v105, s81
    v_perm_b32 v163, v110, v106, s80
    v_perm_b32 v167, v110, v106, s81
    v_perm_b32 v171, v111, v107, s80
    v_perm_b32 v175, v111, v107, s81
    s_nop 1
    v_mfma_f32_16x16x32_bf16 v[176:179], v[236:239], v[144:147], v[176:179]
    v_mfma_f32_16x16x32_bf16 v[180:183], v[236:239], v[148:151], v[180:183]
    v_mfma_f32_16x16x32_bf16 v[184:187], v[236:239], v[152:155], v[184:187]
    v_mfma_f32_16x16x32_bf16 v[188:191], v[236:239], v[156:159], v[188:191]
    v_mfma_f32_16x16x32_bf16 v[192:195], v[236:239], v[160:163], v[192:195]
    v_mfma_f32_16x16x32_bf16 v[196:199], v[236:239], v[164:167], v[196:199]
    v_mfma_f32_16x16x32_bf16 v[200:203], v[236:239], v[168:171], v[200:203]
    v_mfma_f32_16x16x32_bf16 v[204:207], v[236:239], v[172:175], v[204:207]
    s_waitcnt vmcnt(22)
    v_perm_b32 v144, v116, v112, s80
    v_perm_b32 v148, v116, v112, s81
    v_perm_b32 v152, v117, v113, s80
    v_perm_b32 v156, v117, v113, s81
    v_perm_b32 v160, v118, v114, s80
    v_perm_b32 v164, v118, v114, s81
    v_perm_b32 v168, v119, v115, s80
    v_perm_b32 v172, v119, v115, s81
    s_waitcnt vmcnt(20)
    v_perm_b32 v145, v124, v120, s80
    v_perm_b32 v149, v124, v120, s81
    v_perm_b32 v153, v125, v121, s80
    v_perm_b32 v157, v125, v121, s81
    v_perm_b32 v161, v126, v122, s80
    v_perm_b32 v165, v126, v122, s81
    v_perm_b32 v169, v127, v123, s80
    v_perm_b32 v173, v127, v123, s81
    s_waitcnt vmcnt(18)
    v_perm_b32 v146, v132, v128, s80
    v_perm_b32 v150, v132, v128, s81
    v_perm_b32 v154, v133, v129, s80
    v_perm_b32 v158, v133, v129, s81
    v_perm_b32 v162, v134, v130, s80
    v_perm_b32 v166, v134, v130, s81
    v_perm_b32 v170, v135, v131, s80
    v_perm_b32 v174, v135, v131, s81
    s_waitcnt vmcnt(16)
    v_perm_b32 v147, v140, v136, s80
    v_perm_b32 v151, v140, v136, s81
    v_perm_b32 v155, v141, v137, s80
    v_perm_b32 v159, v141, v137, s81
    v_perm_b32 v163, v142, v138, s80
    v_perm_b32 v167, v142, v138, s81
    v_perm_b32 v171, v143, v139, s80
    v_perm_b32 v175, v143, v139, s81
    s_nop 1
    v_mfma_f32_16x16x32_bf16 v[176:179], v[240:243], v[144:147], v[176:179]
    v_mfma_f32_16x16x32_bf16 v[180:183], v[240:243], v[148:151], v[180:183]
    v_mfma_f32_16x16x32_bf16 v[184:187], v[240:243], v[152:155], v[184:187]
    v_mfma_f32_16x16x32_bf16 v[188:191], v[240:243], v[156:159], v[188:191]
    v_mfma_f32_16x16x32_bf16 v[192:195], v[240:243], v[160:163], v[192:195]
    v_mfma_f32_16x16x32_bf16 v[196:199], v[240:243], v[164:167], v[196:199]
    v_mfma_f32_16x16x32_bf16 v[200:203], v[240:243], v[168:171], v[200:203]
    v_mfma_f32_16x16x32_bf16 v[204:207], v[240:243], v[172:175], v[204:207]
    s_waitcnt vmcnt(14)
    v_perm_b32 v144, v20, v16, s80
    v_perm_b32 v148, v20, v16, s81
    v_perm_b32 v152, v21, v17, s80
    v_perm_b32 v156, v21, v17, s81
    v_perm_b32 v160, v22, v18, s80
    v_perm_b32 v164, v22, v18, s81
    v_perm_b32 v168, v23, v19, s80
    v_perm_b32 v172, v23, v19, s81
    s_waitcnt vmcnt(12)
    v_perm_b32 v145, v28, v24, s80
    v_perm_b32 v149, v28, v24, s81
    v_perm_b32 v153, v29, v25, s80
    v_perm_b32 v157, v29, v25, s81
    v_perm_b32 v161, v30, v26, s80
    v_perm_b32 v165, v30, v26, s81
    v_perm_b32 v169, v31, v27, s80
    v_perm_b32 v173, v31, v27, s81
    s_waitcnt vmcnt(10)
    v_perm_b32 v146, v36, v32, s80
    v_perm_b32 v150, v36, v32, s81
    v_perm_b32 v154, v37, v33, s80
    v_perm_b32 v158, v37, v33, s81
    v_perm_b32 v162, v38, v34, s80
    v_perm_b32 v166, v38, v34, s81
    v_perm_b32 v170, v39, v35, s80
    v_perm_b32 v174, v39, v35, s81
    s_waitcnt vmcnt(8)
    v_perm_b32 v147, v44, v40, s80
    v_perm_b32 v151, v44, v40, s81
    v_perm_b32 v155, v45, v41, s80
    v_perm_b32 v159, v45, v41, s81
    v_perm_b32 v163, v46, v42, s80
    v_perm_b32 v167, v46, v42, s81
    v_perm_b32 v171, v47, v43, s80
    v_perm_b32 v175, v47, v43, s81
    s_cmp_lg_u32 s9, 7
    s_cbranch_scc1 L_nolate
    v_mov_b32 v11, 5264
    v_mov_b32 v12, 1
    ds_write_b32 v11, v12 offset:4
L_nolate:
    s_nop 1
    v_mfma_f32_16x16x32_bf16 v[176:179], v[244:247], v[144:147], v[176:179]
    v_mfma_f32_16x16x32_bf16 v[180:183], v[244:247], v[148:151], v[180:183]
    v_mfma_f32_16x16x32_bf16 v[184:187], v[244:247], v[152:155], v[184:187]
    v_mfma_f32_16x16x32_bf16 v[188:191], v[244:247], v[156:159], v[188:191]
    v_mfma_f32_16x16x32_bf16 v[192:195], v[244:247], v[160:163], v[192:195]
    v_mfma_f32_16x16x32_bf16 v[196:199], v[244:247], v[164:167], v[196:199]
    v_mfma_f32_16x16x32_bf16 v[200:203], v[244:247], v[168:171], v[200:203]
    v_mfma_f32_16x16x32_bf16 v[204:207], v[244:247], v[172:175], v[204:207]
    s_waitcnt vmcnt(6)
    v_perm_b32 v144, v52, v48, s80
    v_perm_b32 v148, v52, v48, s81
    v_perm_b32 v152, v53, v49, s80
    v_perm_b32 v156, v53, v49, s81
    v_perm_b32 v160, v54, v50, s80
    v_perm_b32 v164, v54, v50, s81
    v_perm_b32 v168, v55, v51, s80
    v_perm_b32 v172, v55, v51, s81
    s_waitcnt vmcnt(4)
    v_perm_b32 v145, v60, v56, s80
    v_perm_b32 v149, v60, v56, s81
    v_perm_b32 v153, v61, v57, s80
    v_perm_b32 v157, v61, v57, s81
    v_perm_b32 v161, v62, v58, s80
    v_perm_b32 v165, v62, v58, s81
    v_perm_b32 v169, v63, v59, s80
    v_perm_b32 v173, v63, v59, s81
    s_waitcnt vmcnt(2)
    v_perm_b32 v146, v68, v64, s80
    v_perm_b32 v150, v68, v64, s81
    v_perm_b32 v154, v69, v65, s80
    v_perm_b32 v158, v69, v65, s81
    v_perm_b32 v162, v70, v66, s80
    v_perm_b32 v166, v70, v66, s81
    v_perm_b32 v170, v71, v67, s80
    v_perm_b32 v174, v71, v67, s81
    s_waitcnt vmcnt(0)
    v_perm_b32 v147, v76, v72, s80
    v_perm_b32 v151, v76, v72, s81
    v_perm_b32 v155, v77, v73, s80
    v_perm_b32 v159, v77, v73, s81
    v_perm_b32 v163, v78, v74, s80
    v_perm_b32 v167, v78, v74, s81
    v_perm_b32 v171, v79, v75, s80
    v_perm_b32 v175, v79, v75, s81
    s_nop 1
    v_mfma_f32_16x16x32_bf16 v[176:179], v[248:251], v[144:147], v[176:179]
    v_mfma_f32_16x16x32_bf16 v[180:183], v[248:251], v[148:151], v[180:183]
    v_mfma_f32_16x16x32_bf16 v[184:187], v[248:251], v[152:155], v[184:187]
    v_mfma_f32_16x16x32_bf16 v[188:191], v[248:251], v[156:159], v[188:191]
    v_mfma_f32_16x16x32_bf16 v[192:195], v[248:251], v[160:163], v[192:195]
    v_mfma_f32_16x16x32_bf16 v[196:199], v[248:251], v[164:167], v[196:199]
    v_mfma_f32_16x16x32_bf16 v[200:203], v[248:251], v[168:171], v[200:203]
    v_mfma_f32_16x16x32_bf16 v[204:207], v[248:251], v[172:175], v[204:207]
    s_memrealtime s[10:11]
    s_lshl_b32 s15, s9, 11
    v_lshlrev_b32 v14, 7, v2
    v_add_u32 v14, s15, v14
    v_mov_b32 v12, v9
    v_mov_b32 v13, 5248
    s_mov_b64 exec, 0xffff
    ds_write_b128 v14, v[176:179] offset:6144
    ds_write_b128 v14, v[180:183] offset:6160
    ds_write_b128 v14, v[184:187] offset:6176
    ds_write_b128 v14, v[188:191] offset:6192
    ds_write_b128 v14, v[192:195] offset:6208
    ds_write_b128 v14, v[196:199] offset:6224
    ds_write_b128 v14, v[200:203] offset:6240
    ds_write_b128 v14, v[204:207] offset:6256
    s_mov_b64 exec, -1
    v_permlane32_swap_b32 v9, v12
    s_nop 1
    v_add_f32 v9, v9, v12
    v_mov_b32 v12, v9
    s_lshl_b32 s15, s9, 4
    v_lshlrev_b32 v11, 3, v2
    v_permlane16_swap_b32 v9, v12
    v_add_u32 v11, s15, v11
    s_nop 0
    v_add_f32 v9, v9, v12
    s_mov_b64 exec, 3
    ds_write_b64 v11, v[8:9] offset:5120
    s_mov_b64 exec, -1
    s_cmp_ge_u32 s9, 4
    s_cbranch_scc1 L_nowo2
    v_mov_b32 v11, 5264
L_latespin:
    ds_read_b32 v12, v11 offset:4
    s_waitcnt lgkmcnt(0)
    v_readfirstlane_b32 s15, v12
    s_cmp_lg_u32 s15, 0
    s_cbranch_scc1 L_latego
    s_sleep 4
    s_branch L_latespin
L_latego:
    s_lshl_b32 s15, s8, 9
    s_lshl_b32 s88, s4, 5
    s_add_u32 s15, s15, s88
    s_mul_i32 s15, s15, 896
    s_lshl_b32 s88, s9, 8
    s_add_u32 s15, s15, s88
    v_mul_u32_u24 v11, 7168, v4
    v_lshlrev_b32 v12, 4, v3
    v_add_u32 v15, v11, v12
    buffer_load_dwordx4 v[80:83], v15, s[56:59], s15 offen nt
    s_add_u32 s15, s15, 896
    buffer_load_dwordx4 v[84:87], v15, s[56:59], s15 offen nt
    s_add_u32 s15, s15, 896
    buffer_load_dwordx4 v[88:91], v15, s[56:59], s15 offen nt
    s_add_u32 s15, s15, 896
    buffer_load_dwordx4 v[92:95], v15, s[56:59], s15 offen nt
    s_add_u32 s15, s15, 896
    buffer_load_dwordx4 v[96:99], v15, s[56:59], s15 offen nt
    s_add_u32 s15, s15, 896
    buffer_load_dwordx4 v[100:103], v15, s[56:59], s15 offen nt
    s_add_u32 s15, s15, 896
    buffer_load_dwordx4 v[104:107], v15, s[56:59], s15 offen nt
    s_add_u32 s15, s15, 896
    buffer_load_dwordx4 v[108:111], v15, s[56:59], s15 offen nt
L_nowo2:
    s_waitcnt lgkmcnt(0)
    s_mov_b32 s101, s92
    s_xor_b32 s11, s10, s83
    s_barrier
    ds_read_b64 v[252:253], v13
    s_cmp_lt_u32 s9, 4
    s_cbranch_scc1 L_h2
    s_cmp_gt_u32 s9, 5
    s_cbranch_scc1 L_fin
    v_and_b32 v11, 7, v2
    v_lshlrev_b32 v11, 4, v11
    v_bfe_u32 v12, v2, 3, 1
    v_lshlrev_b32 v12, 3, v12
    v_add_u32 v11, v11, v12
    ds_read_b64 v[14:15], v11 offset:5120
    s_sub_u32 s15, s9, 4
    s_lshl_b32 s15, s15, 10
    v_lshlrev_b32 v13, 4, v2
    v_add_u32 v13, s15, v13
    ds_read_b128 v[16:19], v13 offset:6144
    ds_read_b128 v[20:23], v13 offset:8192
    ds_read_b128 v[24:27], v13 offset:10240
    ds_read_b128 v[28:31], v13 offset:12288
    ds_read_b128 v[32:35], v13 offset:14336
    ds_read_b128 v[36:39], v13 offset:16384
    ds_read_b128 v[40:43], v13 offset:18432
    ds_read_b128 v[44:47], v13 offset:20480
    s_lshl_b32 s88, s3, 4
    s_add_u32 s88, s88, s4
    s_mul_i32 s88, s88, 2176
    s_add_u32 s88, s88, 131072
    s_lshr_b32 s15, s15, 2
    s_add_u32 s15, s15, s88
    s_mov_b32 s13, s88
    v_lshlrev_b32 v13, 2, v2
    s_mov_b32 s90, 0x55555555
    s_mov_b32 s91, 0x55555555
    s_waitcnt lgkmcnt(8)
    v_mov_b32 v11, v14
    s_nop 1
    v_max_f32_dpp v11, v11, v11 quad_perm:[1,0,3,2] row_mask:0xf bank_mask:0xf
    s_nop 1
    v_max_f32_dpp v11, v11, v11 quad_perm:[2,3,0,1] row_mask:0xf bank_mask:0xf
    s_nop 1
    v_max_f32_dpp v11, v11, v11 row_half_mirror row_mask:0xf bank_mask:0xf
    s_nop 1
    v_sub_f32 v12, v14, v11
    v_mul_f32 v12, s82, v12
    v_exp_f32 v12, v12
    s_nop 0
    v_mul_f32 v15, v15, v12
    v_readlane_b32 s16, v12, 0
    v_readlane_b32 s17, v12, 1
    v_readlane_b32 s18, v12, 2
    v_readlane_b32 s19, v12, 3
    v_readlane_b32 s20, v12, 4
    v_readlane_b32 s21, v12, 5
    v_readlane_b32 s22, v12, 6
    v_readlane_b32 s23, v12, 7
    v_readlane_b32 s24, v12, 8
    v_readlane_b32 s25, v12, 9
    v_readlane_b32 s26, v12, 10
    v_readlane_b32 s27, v12, 11
    v_readlane_b32 s28, v12, 12
    v_readlane_b32 s29, v12, 13
    v_readlane_b32 s30, v12, 14
    v_readlane_b32 s31, v12, 15
    v_add_f32_dpp v15, v15, v15 quad_perm:[1,0,3,2] row_mask:0xf bank_mask:0xf
    s_nop 1
    v_add_f32_dpp v15, v15, v15 quad_perm:[2,3,0,1] row_mask:0xf bank_mask:0xf
    s_nop 1
    v_add_f32_dpp v15, v15, v15 row_half_mirror row_mask:0xf bank_mask:0xf
    s_nop 1
    v_bfe_u32 v10, v2, 1, 1
    v_mul_lo_u32 v10, v10, s83
    v_xor_b32 v10, s10, v10
    v_mov_b32 v217, v10
    v_mov_b32 v219, v10
    v_mov_b32 v221, v10
    v_mov_b32 v223, v10
    s_waitcnt lgkmcnt(0)
    v_mul_f32 v216, s16, v16
    v_mul_f32 v218, s24, v17
    v_mul_f32 v220, s16, v18
    v_mul_f32 v222, s24, v19
    v_fma_f32 v216, v20, s17, v216
    v_fma_f32 v218, v21, s25, v218
    v_fma_f32 v220, v22, s17, v220
    v_fma_f32 v222, v23, s25, v222
    v_fma_f32 v216, v24, s18, v216
    v_fma_f32 v218, v25, s26, v218
    v_fma_f32 v220, v26, s18, v220
    v_fma_f32 v222, v27, s26, v222
    v_fma_f32 v216, v28, s19, v216
    v_fma_f32 v218, v29, s27, v218
    v_fma_f32 v220, v30, s19, v220
    v_fma_f32 v222, v31, s27, v222
    v_fma_f32 v216, v32, s20, v216
    v_fma_f32 v218, v33, s28, v218
    v_fma_f32 v220, v34, s20, v220
    v_fma_f32 v222, v35, s28, v222
    v_fma_f32 v216, v36, s21, v216
    v_fma_f32 v218, v37, s29, v218
    v_fma_f32 v220, v38, s21, v220
    v_fma_f32 v222, v39, s29, v222
    v_fma_f32 v216, v40, s22, v216
    v_fma_f32 v218, v41, s30, v218
    v_fma_f32 v220, v42, s22, v220
    v_fma_f32 v222, v43, s30, v222
    v_fma_f32 v216, v44, s23, v216
    v_fma_f32 v218, v45, s31, v218
    v_fma_f32 v220, v46, s23, v220
    v_fma_f32 v222, v47, s31, v222
    s_nop 1
    v_mov_b32_dpp v224, v216 quad_perm:[1,1,3,3] row_mask:0xf bank_mask:0xf
    v_mov_b32_dpp v225, v218 quad_perm:[1,1,3,3] row_mask:0xf bank_mask:0xf
    v_mov_b32_dpp v226, v220 quad_perm:[1,1,3,3] row_mask:0xf bank_mask:0xf
    v_mov_b32_dpp v227, v222 quad_perm:[1,1,3,3] row_mask:0xf bank_mask:0xf
    v_cvt_pk_bf16_f32 v216, v216, v224
    v_cvt_pk_bf16_f32 v218, v218, v225
    v_cvt_pk_bf16_f32 v220, v220, v226
    v_cvt_pk_bf16_f32 v222, v222, v227
    s_mov_b64 exec, s[90:91]
    buffer_store_dwordx2 v[216:217], v13, s[60:63], s15 offen offset:0 sc1
    buffer_store_dwordx2 v[218:219], v13, s[60:63], s15 offen offset:1024 sc1
    buffer_store_dwordx2 v[220:221], v13, s[60:63], s15 offen offset:512 sc1
    buffer_store_dwordx2 v[222:223], v13, s[60:63], s15 offen offset:1536 sc1
    s_mov_b64 exec, -1
    s_cmp_lg_u32 s9, 4
    s_cbranch_scc1 L_fin
    v_readlane_b32 s16, v11, 0
    v_readlane_b32 s17, v11, 8
    v_readlane_b32 s18, v15, 0
    v_readlane_b32 s19, v15, 8
    v_and_b32 v13, 1, v2
    v_cmp_eq_u32 vcc, 0, v13
    v_mov_b32 v224, s17
    v_mov_b32 v226, s19
    v_mov_b32 v12, s16
    v_mov_b32 v14, s18
    v_mov_b32 v225, s10
    v_mov_b32 v227, s11
    v_cndmask_b32 v224, v224, v12, vcc
    v_cndmask_b32 v226, v226, v14, vcc
    v_lshlrev_b32 v13, 4, v2
    s_mov_b64 exec, 0xf
    buffer_store_dwordx4 v[224:227], v13, s[60:63], s13 offen offset:2048 sc1
    s_branch L_fin
L_h2:
    v_lshrrev_b32 v11, 1, v4
    v_mul_u32_u24 v11, 112, v11
    v_and_b32 v12, 1, v4
    v_lshlrev_b32 v13, 1, v3
    v_add3_u32 v11, v11, v12, v13
    v_lshlrev_b32 v222, 4, v11
    v_lshrrev_b32 v11, 2, v2
    v_mul_u32_u24 v11, 3584, v11
    v_and_b32 v12, 3, v2
    v_lshlrev_b32 v12, 4, v12
    v_add_u32 v220, v11, v12
    s_mov_b32 s86, 0xffff0000
    s_mov_b32 s87, 0xffff0000
    s_cmp_eq_u32 s9, 3
    s_cselect_b32 s90, 0x00ff00ff, -1
    s_cselect_b32 s91, 0x00ff00ff, -1
    s_cmp_lg_u32 s9, 0
    s_cbranch_scc1 L_h2wait
    s_mul_i32 s15, s3, 34816
    s_add_u32 s15, s15, 131072
    s_lshl_b32 s88, s5, 4
    s_add_u32 s88, s88, s15
    s_lshl_b32 s14, s4, 7
    s_add_u32 s15, s15, s14
    v_mul_u32_u24 v11, 2176, v3
    v_lshlrev_b32 v12, 5, v4
    v_add_u32 v12, v11, v12
    s_mov_b32 s89, 0
    s_waitcnt vmcnt(0)
    v_perm_b32 v16, v84, v80, s80
    v_perm_b32 v20, v84, v80, s81
    v_perm_b32 v24, v85, v81, s80
    v_perm_b32 v28, v85, v81, s81
    v_perm_b32 v32, v86, v82, s80
    v_perm_b32 v36, v86, v82, s81
    v_perm_b32 v40, v87, v83, s80
    v_perm_b32 v44, v87, v83, s81
    v_perm_b32 v17, v92, v88, s80
    v_perm_b32 v21, v92, v88, s81
    v_perm_b32 v25, v93, v89, s80
    v_perm_b32 v29, v93, v89, s81
    v_perm_b32 v33, v94, v90, s80
    v_perm_b32 v37, v94, v90, s81
    v_perm_b32 v41, v95, v91, s80
    v_perm_b32 v45, v95, v91, s81
    v_perm_b32 v18, v100, v96, s80
    v_perm_b32 v22, v100, v96, s81
    v_perm_b32 v26, v101, v97, s80
    v_perm_b32 v30, v101, v97, s81
    v_perm_b32 v34, v102, v98, s80
    v_perm_b32 v38, v102, v98, s81
    v_perm_b32 v42, v103, v99, s80
    v_perm_b32 v46, v103, v99, s81
    v_perm_b32 v19, v108, v104, s80
    v_perm_b32 v23, v108, v104, s81
    v_perm_b32 v27, v109, v105, s80
    v_perm_b32 v31, v109, v105, s81
    v_perm_b32 v35, v110, v106, s80
    v_perm_b32 v39, v110, v106, s81
    v_perm_b32 v43, v111, v107, s80
    v_perm_b32 v47, v111, v107, s81
L_h2poll:
    buffer_load_dwordx4 v[144:147], v12, s[60:63], s15 offen offset:0 sc1
    buffer_load_dwordx4 v[148:151], v12, s[60:63], s15 offen offset:16 sc1
    buffer_load_dwordx4 v[152:155], v11, s[60:63], s88 offen offset:2048 sc1
    s_waitcnt vmcnt(0)
    v_xor_b32 v14, v145, v147
    v_xor_b32 v14, s83, v14
    v_subrev_u32 v145, s101, v145
    v_lshrrev_b32 v145, 24, v145
    v_or_b32 v13, v14, v145
    v_xor_b32 v14, v149, v151
    v_xor_b32 v14, s83, v14
    v_subrev_u32 v149, s101, v149
    v_lshrrev_b32 v149, 24, v149
    v_or3_b32 v13, v13, v14, v149
    v_xor_b32 v14, v153, v155
    v_xor_b32 v14, s83, v14
    v_subrev_u32 v153, s101, v153
    v_lshrrev_b32 v153, 24, v153
    v_or3_b32 v13, v13, v14, v153
    v_cmp_ne_u32 vcc, 0, v13
    s_cbranch_vccz L_h2got
    s_add_u32 s89, s89, 1
    s_cmp_lt_u32 s89, 400000
    s_cbranch_scc1 L_h2poll
L_h2got:
    v_mov_b32 v13, v152
    v_lshlrev_b32 v156, 16, v144
    v_and_b32 v157, 0xffff0000, v144
    v_lshlrev_b32 v158, 16, v146
    v_and_b32 v159, 0xffff0000, v146
    v_lshlrev_b32 v160, 16, v148
    v_and_b32 v161, 0xffff0000, v148
    v_lshlrev_b32 v162, 16, v150
    v_and_b32 v163, 0xffff0000, v150
    v_max_f32_dpp v13, v13, v13 quad_perm:[1,0,3,2] row_mask:0xf bank_mask:0xf
    s_nop 1
    v_max_f32_dpp v13, v13, v13 quad_perm:[2,3,0,1] row_mask:0xf bank_mask:0xf
    s_nop 1
    v_max_f32_dpp v13, v13, v13 row_half_mirror row_mask:0xf bank_mask:0xf
    s_nop 1
    v_sub_f32 v13, v152, v13
    v_mul_f32 v13, s82, v13
    v_exp_f32 v13, v13
    s_nop 0
    v_mul_f32 v14, v13, v154
    v_mul_f32 v156, v13, v156
    v_mul_f32 v157, v13, v157
    v_mul_f32 v158, v13, v158
    v_mul_f32 v159, v13, v159
    v_mul_f32 v160, v13, v160
    v_mul_f32 v161, v13, v161
    v_mul_f32 v162, v13, v162
    v_mul_f32 v163, v13, v163
    v_add_f32_dpp v14, v14, v14 quad_perm:[1,0,3,2] row_mask:0xf bank_mask:0xf
    v_add_f32_dpp v156, v156, v156 quad_perm:[1,0,3,2] row_mask:0xf bank_mask:0xf
    v_add_f32_dpp v157, v157, v157 quad_perm:[1,0,3,2] row_mask:0xf bank_mask:0xf
    v_add_f32_dpp v158, v158, v158 quad_perm:[1,0,3,2] row_mask:0xf bank_mask:0xf
    v_add_f32_dpp v159, v159, v159 quad_perm:[1,0,3,2] row_mask:0xf bank_mask:0xf
    v_add_f32_dpp v160, v160, v160 quad_perm:[1,0,3,2] row_mask:0xf bank_mask:0xf
    v_add_f32_dpp v161, v161, v161 quad_perm:[1,0,3,2] row_mask:0xf bank_mask:0xf
    v_add_f32_dpp v162, v162, v162 quad_perm:[1,0,3,2] row_mask:0xf bank_mask:0xf
    v_add_f32_dpp v163, v163, v163 quad_perm:[1,0,3,2] row_mask:0xf bank_mask:0xf
    v_add_f32_dpp v14, v14, v14 quad_perm:[2,3,0,1] row_mask:0xf bank_mask:0xf
    v_add_f32_dpp v156, v156, v156 quad_perm:[2,3,0,1] row_mask:0xf bank_mask:0xf
    v_add_f32_dpp v157, v157, v157 quad_perm:[2,3,0,1] row_mask:0xf bank_mask:0xf
    v_add_f32_dpp v158, v158, v158 quad_perm:[2,3,0,1] row_mask:0xf bank_mask:0xf
    v_add_f32_dpp v159, v159, v159 quad_perm:[2,3,0,1] row_mask:0xf bank_mask:0xf
    v_add_f32_dpp v160, v160, v160 quad_perm:[2,3,0,1] row_mask:0xf bank_mask:0xf
    v_add_f32_dpp v161, v161, v161 quad_perm:[2,3,0,1] row_mask:0xf bank_mask:0xf
    v_add_f32_dpp v162, v162, v162 quad_perm:[2,3,0,1] row_mask:0xf bank_mask:0xf
    v_add_f32_dpp v163, v163, v163 quad_perm:[2,3,0,1] row_mask:0xf bank_mask:0xf
    v_add_f32_dpp v14, v14, v14 row_half_mirror row_mask:0xf bank_mask:0xf
    v_add_f32_dpp v156, v156, v156 row_half_mirror row_mask:0xf bank_mask:0xf
    v_add_f32_dpp v157, v157, v157 row_half_mirror row_mask:0xf bank_mask:0xf
    v_add_f32_dpp v158, v158, v158 row_half_mirror row_mask:0xf bank_mask:0xf
    v_add_f32_dpp v159, v159, v159 row_half_mirror row_mask:0xf bank_mask:0xf
    v_add_f32_dpp v160, v160, v160 row_half_mirror row_mask:0xf bank_mask:0xf
    v_add_f32_dpp v161, v161, v161 row_half_mirror row_mask:0xf bank_mask:0xf
    v_add_f32_dpp v162, v162, v162 row_half_mirror row_mask:0xf bank_mask:0xf
    v_add_f32_dpp v163, v163, v163 row_half_mirror row_mask:0xf bank_mask:0xf
    v_cmp_gt_u32 vcc, 8, v3
    v_rcp_f32 v14, v14
    s_waitcnt lgkmcnt(0)
    v_cndmask_b32 v15, v253, v252, vcc
    v_mul_f32 v14, v14, v15
    v_mul_f32 v156, v14, v156
    v_mul_f32 v157, v14, v157
    v_mul_f32 v158, v14, v158
    v_mul_f32 v159, v14, v159
    v_mul_f32 v160, v14, v160
    v_mul_f32 v161, v14, v161
    v_mul_f32 v162, v14, v162
    v_mul_f32 v163, v14, v163
    v_cvt_pk_bf16_f32 v208, v156, v157
    v_cvt_pk_bf16_f32 v209, v158, v159
    v_cvt_pk_bf16_f32 v210, v160, v161
    v_cvt_pk_bf16_f32 v211, v162, v163
    v_lshlrev_b32 v11, 4, v2
    ds_write_b128 v11, v[208:211] offset:4096
    s_waitcnt lgkmcnt(0)
    s_barrier
    s_branch L_h2go
L_h2wait:
    s_waitcnt vmcnt(0)
    v_perm_b32 v16, v84, v80, s80
    v_perm_b32 v20, v84, v80, s81
    v_perm_b32 v24, v85, v81, s80
    v_perm_b32 v28, v85, v81, s81
    v_perm_b32 v32, v86, v82, s80
    v_perm_b32 v36, v86, v82, s81
    v_perm_b32 v40, v87, v83, s80
    v_perm_b32 v44, v87, v83, s81
    v_perm_b32 v17, v92, v88, s80
    v_perm_b32 v21, v92, v88, s81
    v_perm_b32 v25, v93, v89, s80
    v_perm_b32 v29, v93, v89, s81
    v_perm_b32 v33, v94, v90, s80
    v_perm_b32 v37, v94, v90, s81
    v_perm_b32 v41, v95, v91, s80
    v_perm_b32 v45, v95, v91, s81
    v_perm_b32 v18, v100, v96, s80
    v_perm_b32 v22, v100, v96, s81
    v_perm_b32 v26, v101, v97, s80
    v_perm_b32 v30, v101, v97, s81
    v_perm_b32 v34, v102, v98, s80
    v_perm_b32 v38, v102, v98, s81
    v_perm_b32 v42, v103, v99, s80
    v_perm_b32 v46, v103, v99, s81
    v_perm_b32 v19, v108, v104, s80
    v_perm_b32 v23, v108, v104, s81
    v_perm_b32 v27, v109, v105, s80
    v_perm_b32 v31, v109, v105, s81
    v_perm_b32 v35, v110, v106, s80
    v_perm_b32 v39, v110, v106, s81
    v_perm_b32 v43, v111, v107, s80
    v_perm_b32 v47, v111, v107, s81
    v_lshlrev_b32 v11, 4, v2
    s_barrier
    ds_read_b128 v[208:211], v11 offset:4096
    s_waitcnt lgkmcnt(0)
L_h2go:
    v_mfma_f32_16x16x32_bf16 v[176:179], v[208:211], v[16:19], 0
    v_mfma_f32_16x16x32_bf16 v[180:183], v[208:211], v[20:23], 0
    v_mfma_f32_16x16x32_bf16 v[184:187], v[208:211], v[24:27], 0
    v_mfma_f32_16x16x32_bf16 v[188:191], v[208:211], v[28:31], 0
    v_mfma_f32_16x16x32_bf16 v[192:195], v[208:211], v[32:35], 0
    v_mfma_f32_16x16x32_bf16 v[196:199], v[208:211], v[36:39], 0
    v_mfma_f32_16x16x32_bf16 v[200:203], v[208:211], v[40:43], 0
    v_mfma_f32_16x16x32_bf16 v[204:207], v[208:211], v[44:47], 0
    s_mul_i32 s15, s2, 3584
    s_lshl_b32 s88, s9, 9
    s_add_u32 s15, s15, s88
    s_add_u32 s15, s15, 2097152
    v_mov_b32 v145, s10
    v_mov_b32 v147, s11
    s_nop 4
    v_cndmask_b32 v152, v176, v192, s[86:87]
    v_cndmask_b32 v153, v180, v196, s[86:87]
    v_cndmask_b32 v154, v184, v200, s[86:87]
    v_cndmask_b32 v155, v188, v204, s[86:87]
    v_cvt_pk_bf16_f32 v144, v152, v153
    v_cvt_pk_bf16_f32 v146, v154, v155
    s_mov_b64 exec, s[90:91]
    buffer_store_dwordx4 v[144:147], v222, s[60:63], s15 offen sc1
    s_mov_b64 exec, -1
    s_cmp_ge_u32 s2, 56
    s_cbranch_scc1 L_fin
    s_lshl_b32 s15, s2, 6
    s_mul_i32 s88, s9, 229376
    s_add_u32 s15, s15, s88
    s_add_u32 s15, s15, 2097152
    s_mov_b32 s89, 0
L_h3poll:
    s_mov_b32 s88, s15
    buffer_load_dwordx4 v[48:51], v220, s[60:63], s88 offen sc1
    s_add_u32 s88, s88, 57344
    buffer_load_dwordx4 v[52:55], v220, s[60:63], s88 offen sc1
    s_add_u32 s88, s88, 57344
    buffer_load_dwordx4 v[56:59], v220, s[60:63], s88 offen sc1
    s_add_u32 s88, s88, 57344
    buffer_load_dwordx4 v[60:63], v220, s[60:63], s88 offen sc1
    s_waitcnt vmcnt(0)
    v_xor_b32 v14, v49, v51
    v_xor_b32 v14, s83, v14
    v_subrev_u32 v49, s101, v49
    v_lshrrev_b32 v49, 24, v49
    v_or_b32 v13, v14, v49
    v_xor_b32 v14, v53, v55
    v_xor_b32 v14, s83, v14
    v_subrev_u32 v53, s101, v53
    v_lshrrev_b32 v53, 24, v53
    v_or3_b32 v13, v13, v14, v53
    v_xor_b32 v14, v57, v59
    v_xor_b32 v14, s83, v14
    v_subrev_u32 v57, s101, v57
    v_lshrrev_b32 v57, 24, v57
    v_or3_b32 v13, v13, v14, v57
    v_xor_b32 v14, v61, v63
    v_xor_b32 v14, s83, v14
    v_subrev_u32 v61, s101, v61
    v_lshrrev_b32 v61, 24, v61
    v_or3_b32 v13, v13, v14, v61
    v_cmp_ne_u32 vcc, 0, v13
    s_cbranch_vccz L_h3got
    s_add_u32 s89, s89, 1
    s_cmp_lt_u32 s89, 400000
    s_cbranch_scc1 L_h3poll
L_h3got:
    v_lshlrev_b32 v64, 16, v48
    v_and_b32 v65, 0xffff0000, v48
    v_lshlrev_b32 v66, 16, v50
    v_and_b32 v67, 0xffff0000, v50
    v_lshlrev_b32 v13, 16, v52
    v_and_b32 v14, 0xffff0000, v52
    v_add_f32 v64, v64, v13
    v_add_f32 v65, v65, v14
    v_lshlrev_b32 v13, 16, v54
    v_and_b32 v14, 0xffff0000, v54
    v_add_f32 v66, v66, v13
    v_add_f32 v67, v67, v14
    v_lshlrev_b32 v13, 16, v56
    v_and_b32 v14, 0xffff0000, v56
    v_add_f32 v64, v64, v13
    v_add_f32 v65, v65, v14
    v_lshlrev_b32 v13, 16, v58
    v_and_b32 v14, 0xffff0000, v58
    v_add_f32 v66, v66, v13
    v_add_f32 v67, v67, v14
    v_lshlrev_b32 v13, 16, v60
    v_and_b32 v14, 0xffff0000, v60
    v_add_f32 v64, v64, v13
    v_add_f32 v65, v65, v14
    v_lshlrev_b32 v13, 16, v62
    v_and_b32 v14, 0xffff0000, v62
    v_add_f32 v66, v66, v13
    v_add_f32 v67, v67, v14
    s_nop 1
    v_add_f32_dpp v64, v64, v64 row_ror:4 row_mask:0xf bank_mask:0xf
    v_add_f32_dpp v65, v65, v65 row_ror:4 row_mask:0xf bank_mask:0xf
    v_add_f32_dpp v66, v66, v66 row_ror:4 row_mask:0xf bank_mask:0xf
    v_add_f32_dpp v67, v67, v67 row_ror:4 row_mask:0xf bank_mask:0xf
    s_nop 1
    v_add_f32_dpp v64, v64, v64 row_ror:8 row_mask:0xf bank_mask:0xf
    v_add_f32_dpp v65, v65, v65 row_ror:8 row_mask:0xf bank_mask:0xf
    v_add_f32_dpp v66, v66, v66 row_ror:8 row_mask:0xf bank_mask:0xf
    v_add_f32_dpp v67, v67, v67 row_ror:8 row_mask:0xf bank_mask:0xf
    s_nop 1
    v_mov_b32 v68, v64
    v_mov_b32 v69, v65
    v_mov_b32 v70, v66
    v_mov_b32 v71, v67
    s_nop 1
    v_permlane16_swap_b32 v64, v68
    v_permlane16_swap_b32 v65, v69
    v_permlane16_swap_b32 v66, v70
    v_permlane16_swap_b32 v67, v71
    s_nop 1
    v_add_f32 v64, v64, v68
    v_add_f32 v65, v65, v69
    v_add_f32 v66, v66, v70
    v_add_f32 v67, v67, v71
    s_nop 1
    v_mov_b32 v68, v64
    v_mov_b32 v69, v65
    v_mov_b32 v70, v66
    v_mov_b32 v71, v67
    s_nop 1
    v_permlane32_swap_b32 v64, v68
    v_permlane32_swap_b32 v65, v69
    v_permlane32_swap_b32 v66, v70
    v_permlane32_swap_b32 v67, v71
    s_nop 1
    v_add_f32 v64, v64, v68
    v_add_f32 v65, v65, v69
    v_add_f32 v66, v66, v70
    v_add_f32 v67, v67, v71
    s_nop 1
    s_lshl_b32 s15, s9, 6
    v_lshlrev_b32 v11, 4, v2
    v_add_u32 v12, s15, v11
    s_mov_b64 exec, 0xf
    ds_write_b128 v12, v[64:67] offset:5312
    s_waitcnt lgkmcnt(0)
    s_barrier
    s_cmp_lg_u32 s9, 0
    s_cbranch_scc1 L_fin
    ds_read_b128 v[72:75], v11 offset:5312
    ds_read_b128 v[76:79], v11 offset:5376
    ds_read_b128 v[80:83], v11 offset:5440
    ds_read_b128 v[84:87], v11 offset:5504
    s_waitcnt lgkmcnt(0)
    v_add_f32 v72, v72, v76
    v_add_f32 v80, v80, v84
    v_add_f32 v73, v73, v77
    v_add_f32 v81, v81, v85
    v_add_f32 v74, v74, v78
    v_add_f32 v82, v82, v86
    v_add_f32 v75, v75, v79
    v_add_f32 v83, v83, v87
    v_add_f32 v72, v72, v80
    v_add_f32 v73, v73, v81
    v_add_f32 v74, v74, v82
    v_add_f32 v75, v75, v83
    v_cvt_pk_bf16_f32 v72, v72, v73
    v_cvt_pk_bf16_f32 v73, v74, v75
    s_lshl_b32 s15, s2, 5
    v_lshlrev_b32 v11, 3, v2
    buffer_store_dwordx2 v[72:73], v11, s[72:75], s15 offen
L_fin:
L_end:
    s_endpgm
.section .rodata,"a"
.p2align 6
.amdhsa_kernel gated_mix__gqa_block_cached__gqa_block_cached__decode_kernel
  .amdhsa_next_free_vgpr 256
  .amdhsa_next_free_sgpr 102
  .amdhsa_accum_offset 256
  .amdhsa_group_segment_fixed_size 0
  .amdhsa_kernarg_size 112
  .amdhsa_user_sgpr_count 2
  .amdhsa_user_sgpr_kernarg_segment_ptr 1
  .amdhsa_system_sgpr_workgroup_id_x 1
.end_amdhsa_kernel
```
